```python
import torch

def _softmax(x, axis=-1):
    return torch.softmax(x, dim=axis)
def _gelu(x):
    return torch.nn.functional.gelu(x, approximate="tanh")
def _silu(x):
    return torch.nn.functional.silu(x)
def _sigmoid(x):
    return torch.sigmoid(x)
def _layernorm(x, axis=-1, eps=1e-5):
    m = x.mean(dim=axis, keepdim=True)
    v = x.var(dim=axis, keepdim=True, unbiased=False)
    return (x - m) / torch.sqrt(v + eps)
def _scatter_add(tgt, idx, src, axis=0):
    return tgt.clone().index_add_(axis, idx, src)
def _segment_sum(src, seg, n):
    out = torch.zeros((n,) + src.shape[1:], dtype=src.dtype)
    return out.index_add_(0, seg, src)
def _pad(x, pw):
    flat = tuple(v for pair in reversed(pw) for v in pair)
    return torch.nn.functional.pad(x, flat)

kernel_name = 'concat_heads__sliding_block_cached__mha_block_cached__decode'

def setup_inputs():

    _w = (lambda a: (lambda t: t.to(torch.bfloat16) if t.is_floating_point() else t)(torch.as_tensor(a)))
    def _A_setup():
        B, Sq, D = 4, 1, 512
        Hq, Hkv, Sk, Dh = 32, 8, 8192, 128
        assert Hq % Hkv == 0, (Hq, Hkv)
        return {
            "x": _w((lambda *s: torch.randn(*s, dtype=torch.bfloat16) * 0.8)(B, Sq, D)),
            "k_cache": _w((lambda *s: torch.randn(*s, dtype=torch.bfloat16) * 1.6)(B, Hkv, Sk, Dh)),
            "v_cache": _w((lambda *s: torch.randn(*s, dtype=torch.bfloat16) * 0.2)(B, Hkv, Sk, Dh)),
            "wq": _w((lambda *s: torch.randn(*s, dtype=torch.bfloat16) * 1.6)(D, Hq * Dh) * (D ** -0.5)),
            "wo": _w((lambda *s: torch.randn(*s, dtype=torch.bfloat16) * 0.2)(Hq * Dh, D) * ((Hq * Dh) ** -0.5)),
        }
    _A_in = _A_setup()

    def _B_setup():
        B, Sq, D = 4, 1, 512
        H, Sk, Dh = 32, 8192, 128
        return {
            "x": _w((lambda *s: torch.randn(*s, dtype=torch.bfloat16) * 0.8)(B, Sq, D)),
            "k_cache": _w((lambda *s: torch.randn(*s, dtype=torch.bfloat16) * 1.6)(B, H, Sk, Dh)),
            "v_cache": _w((lambda *s: torch.randn(*s, dtype=torch.bfloat16) * 0.2)(B, H, Sk, Dh)),
            "wq": _w((lambda *s: torch.randn(*s, dtype=torch.bfloat16) * 1.6)(D, H * Dh) * (D ** -0.5)),
            "wo": _w((lambda *s: torch.randn(*s, dtype=torch.bfloat16) * 0.2)(H * Dh, D) * ((H * Dh) ** -0.5)),
        }
    _B_in = _B_setup()

    return {
        "A_x": _A_in["x"],
        "A_k_cache": _A_in["k_cache"],
        "A_v_cache": _A_in["v_cache"],
        "A_wq": _A_in["wq"],
        "A_wo": _A_in["wo"],
        "B_x": _B_in["x"],
        "B_k_cache": _B_in["k_cache"],
        "B_v_cache": _B_in["v_cache"],
        "B_wq": _B_in["wq"],
        "B_wo": _B_in["wo"],
    }

def reference(A_x, A_k_cache, A_v_cache, A_wq, A_wo, B_x, B_k_cache, B_v_cache, B_wq, B_wo):
    def _A_ref(x, k_cache, v_cache, wq, wo):
        B, Sq, D = x.shape
        Hq, Dh = 32, 128
        Hkv, Sk = k_cache.shape[1], k_cache.shape[2]
        W = min(4096, max(256, Sk // 4))
        rep = Hq // Hkv
        q = (lambda x, *d: x.permute(*d))((x @ wq).reshape(B, Sq, Hq, Dh), 0, 2, 1, 3)
        k = (lambda x, n, axis: torch.repeat_interleave(x, n, dim=axis))(k_cache[:, :, Sk - W:, :], rep, axis=1)
        v = (lambda x, n, axis: torch.repeat_interleave(x, n, dim=axis))(v_cache[:, :, Sk - W:, :], rep, axis=1)
        scores = torch.einsum("bhqd,bhkd->bhqk", q, k) * (Dh ** -0.5)
        p = _softmax(scores, axis=-1)
        o = torch.einsum("bhqk,bhkd->bhqd", p, v)
        return (lambda x, *d: x.permute(*d))(o, 0, 2, 1, 3).reshape(B, Sq, Hq * Dh) @ wo

    def _B_ref(x, k_cache, v_cache, wq, wo):
        B, Sq, D = x.shape
        H, Dh = 32, 128
        q = (lambda x, *d: x.permute(*d))((x @ wq).reshape(B, Sq, H, Dh), 0, 2, 1, 3)
        scores = torch.einsum("bhqd,bhkd->bhqk", q, k_cache) * (Dh ** -0.5)
        p = _softmax(scores, axis=-1)
        o = torch.einsum("bhqk,bhkd->bhqd", p, v_cache)
        return (lambda x, *d: x.permute(*d))(o, 0, 2, 1, 3).reshape(B, Sq, H * Dh) @ wo

    a = _A_ref(A_x, A_k_cache, A_v_cache, A_wq, A_wo)
    b = _B_ref(B_x, B_k_cache, B_v_cache, B_wq, B_wo)
    return torch.concatenate([a, b], axis=-1)
```

```asm
; @launch grid=(256,1,1) block=(256,1,1) lds=98560
.amdgcn_target "amdgcn-amd-amdhsa--gfx950"
.text
.globl concat_heads__sliding_block_cached__mha_block_cached__decode_kernel
.p2align 8
.type concat_heads__sliding_block_cached__mha_block_cached__decode_kernel,@function
concat_heads__sliding_block_cached__mha_block_cached__decode_kernel:
    s_cmp_ge_u32 s2, 256
    s_cbranch_scc1 L_EXIT
    s_and_b32 s40, s2, 7
    s_lshr_b32 s41, s2, 3
    s_cmp_lt_u32 s41, 4
    s_cbranch_scc1 A_PATH
    s_sub_u32 s41, s41, 4
    s_load_dwordx2 s[4:5], s[0:1], 40
    s_load_dwordx8 s[24:31], s[0:1], 48
    s_load_dwordx4 s[32:35], s[0:1], 88
    v_lshrrev_b32 v1, 6, v0
    v_and_b32 v2, 63, v0
    v_readfirstlane_b32 s3, v1
    v_lshrrev_b32 v3, 4, v2
    v_and_b32 v58, 15, v0
    s_mul_i32 s52, s41, 37
    s_lshr_b32 s52, s52, 8
    s_lshl_b32 s40, s40, 2
    s_add_u32 s40, s40, s52
    s_mul_i32 s52, s52, 7
    s_sub_u32 s41, s41, s52
    s_mul_i32 s52, s41, 74899
    s_add_u32 s53, s52, 74899
    s_add_u32 s52, s52, 0
    s_add_u32 s53, s53, 0
    s_lshr_b32 s52, s52, 10
    s_lshr_b32 s53, s53, 10
    s_lshl_b32 s52, s52, 2
    s_lshl_b32 s53, s53, 2
    s_lshr_b32 s42, s52, 9
    s_add_u32 s52, s52, s3
    s_sub_u32 s44, s53, s52
    s_add_u32 s44, s44, 3
    s_lshr_b32 s44, s44, 2
    s_and_b32 s52, s52, 511
    s_sub_u32 s43, 515, s52
    s_lshr_b32 s43, s43, 2
    s_min_u32 s43, s43, s44
    s_sub_u32 s44, s44, s43
    s_lshl_b32 s53, s42, 5
    s_add_u32 s53, s53, s40
    s_lshl_b32 s53, s53, 21
    s_lshl_b32 s45, s52, 12
    s_add_u32 s45, s45, s53
    s_lshl_b32 s46, s43, 14
    s_add_u32 s46, s46, s45
    s_add_u32 s47, s46, 0x3e00000
    s_lshl_b32 s53, s44, 14
    s_add_u32 s53, s53, s47
    s_cmp_eq_u32 s44, 0
    s_cselect_b32 s48, s46, s53
    s_cselect_b32 s46, -1, s46
    v_lshlrev_b32 v1, 4, v2
    v_bfe_u32 v47, v0, 3, 1
    v_add_u32 v47, s42, v47
    v_lshlrev_b32 v47, 10, v47
    s_lshl_b32 s52, s3, 8
    v_lshl_add_u32 v60, v3, 6, s52
    v_add_u32 v60, v60, v47
    s_lshl_b32 s52, s3, 20
    s_lshl_b32 s53, s40, 8
    s_add_u32 s52, s52, s53
    v_lshl_add_u32 v61, v3, 18, s52
    v_lshl_add_u32 v61, v58, 4, v61
    s_waitcnt lgkmcnt(0)
    s_mov_b32 s20, s4
    s_mov_b32 s21, s5
    s_mov_b32 s22, 0x1000
    s_mov_b32 s23, 0x20000
    s_mov_b32 s16, s28
    s_mov_b32 s17, s29
    s_mov_b32 s18, 0x400000
    s_mov_b32 s19, 0x20000
    s_and_b32 s52, s41, 3
    s_lshl_b32 s77, s52, 16
    s_lshl_b32 s52, s52, 4
    s_add_u32 s53, s52, 0
    s_and_b32 s53, s53, 63
    buffer_load_dwordx4 v[192:195], v60, s[20:23], s53 offen
    s_add_u32 s53, s52, 16
    s_and_b32 s53, s53, 63
    buffer_load_dwordx4 v[196:199], v60, s[20:23], s53 offen
    s_add_u32 s53, s52, 32
    s_and_b32 s53, s53, 63
    buffer_load_dwordx4 v[200:203], v60, s[20:23], s53 offen
    s_add_u32 s53, s52, 48
    s_and_b32 s53, s53, 63
    buffer_load_dwordx4 v[204:207], v60, s[20:23], s53 offen
    s_mov_b32 s8, s24
    s_mov_b32 s9, s25
    s_mov_b32 s10, 0x10000000
    s_mov_b32 s11, 0x20000
    s_mov_b32 s96, 0x10000000
    s_mov_b32 s97, s45
    s_mov_b32 s98, s43
    s_mov_b32 s99, s44
    s_mov_b32 s100, 0
    s_add_u32 s58, s77, 0x0
    s_and_b32 s58, s58, 0x3ffff
    buffer_load_dwordx4 a[0:3], v61, s[16:19], s58 offen
    s_add_u32 s58, s77, 0x2000
    s_and_b32 s58, s58, 0x3ffff
    buffer_load_dwordx4 a[4:7], v61, s[16:19], s58 offen
    s_add_u32 s58, s77, 0x4000
    s_and_b32 s58, s58, 0x3ffff
    buffer_load_dwordx4 a[8:11], v61, s[16:19], s58 offen
    s_add_u32 s58, s77, 0x6000
    s_and_b32 s58, s58, 0x3ffff
    buffer_load_dwordx4 a[12:15], v61, s[16:19], s58 offen
    s_add_u32 s58, s77, 0x8000
    s_and_b32 s58, s58, 0x3ffff
    buffer_load_dwordx4 a[16:19], v61, s[16:19], s58 offen
    s_add_u32 s58, s77, 0xa000
    s_and_b32 s58, s58, 0x3ffff
    buffer_load_dwordx4 a[20:23], v61, s[16:19], s58 offen
    s_add_u32 s58, s77, 0xc000
    s_and_b32 s58, s58, 0x3ffff
    buffer_load_dwordx4 a[24:27], v61, s[16:19], s58 offen
    s_add_u32 s58, s77, 0xe000
    s_and_b32 s58, s58, 0x3ffff
    buffer_load_dwordx4 a[28:31], v61, s[16:19], s58 offen
    s_add_u32 s58, s77, 0x10000
    s_and_b32 s58, s58, 0x3ffff
    buffer_load_dwordx4 a[32:35], v61, s[16:19], s58 offen
    s_add_u32 s58, s77, 0x12000
    s_and_b32 s58, s58, 0x3ffff
    buffer_load_dwordx4 a[36:39], v61, s[16:19], s58 offen
    s_add_u32 s58, s77, 0x14000
    s_and_b32 s58, s58, 0x3ffff
    buffer_load_dwordx4 a[40:43], v61, s[16:19], s58 offen
    s_add_u32 s58, s77, 0x16000
    s_and_b32 s58, s58, 0x3ffff
    buffer_load_dwordx4 a[44:47], v61, s[16:19], s58 offen
    v_and_b32 v47, 1, v0
    v_bfe_u32 v48, v0, 1, 2
    v_cmp_eq_u32 vcc, 1, v47
    v_mov_b32 v49, 0x0c0c0100
    v_mov_b32 v59, 0x01000c0c
    v_cndmask_b32 v49, v49, v59, vcc
    v_mov_b32 v47, 0x0c0c0302
    v_mov_b32 v59, 0x03020c0c
    v_cndmask_b32 v47, v47, v59, vcc
    v_mov_b32 v59, 0x0c0c0c0c
    v_cmp_eq_u32 vcc, 0, v48
    s_nop 1
    v_cndmask_b32 v240, v59, v49, vcc
    v_cndmask_b32 v244, v59, v47, vcc
    v_cmp_eq_u32 vcc, 1, v48
    s_nop 1
    v_cndmask_b32 v241, v59, v49, vcc
    v_cndmask_b32 v245, v59, v47, vcc
    v_cmp_eq_u32 vcc, 2, v48
    s_nop 1
    v_cndmask_b32 v242, v59, v49, vcc
    v_cndmask_b32 v246, v59, v47, vcc
    v_cmp_eq_u32 vcc, 3, v48
    s_nop 1
    v_cndmask_b32 v243, v59, v49, vcc
    v_cndmask_b32 v247, v59, v47, vcc
    v_and_b32 v47, 1, v0
    v_cmp_eq_u32 vcc, 1, v47
    v_mov_b32 v48, 0xffff
    v_mov_b32 v49, 0xffff0000
    v_cndmask_b32 v48, v48, v49, vcc
    v_lshrrev_b32 v47, 1, v58
    v_cmp_eq_u32 vcc, 0, v47
    s_nop 1
    v_cndmask_b32 v12, 0, v48, vcc
    v_cmp_eq_u32 vcc, 1, v47
    s_nop 1
    v_cndmask_b32 v13, 0, v48, vcc
    v_cmp_eq_u32 vcc, 2, v47
    s_nop 1
    v_cndmask_b32 v14, 0, v48, vcc
    v_cmp_eq_u32 vcc, 3, v47
    s_nop 1
    v_cndmask_b32 v15, 0, v48, vcc
    v_cmp_eq_u32 vcc, 4, v47
    s_nop 1
    v_cndmask_b32 v16, 0, v48, vcc
    v_cmp_eq_u32 vcc, 5, v47
    s_nop 1
    v_cndmask_b32 v17, 0, v48, vcc
    v_cmp_eq_u32 vcc, 6, v47
    s_nop 1
    v_cndmask_b32 v18, 0, v48, vcc
    v_cmp_eq_u32 vcc, 7, v47
    s_nop 1
    v_cndmask_b32 v19, 0, v48, vcc
    s_mov_b32 s54, 0x3fb8aa3b
    s_mov_b32 s55, 0x3db504f3
    s_mov_b32 s56, 0xffff0000
    s_lshl_b32 s52, s40, 17
    s_lshl_b32 s53, s3, 8
    s_add_u32 s52, s52, s53
    v_lshl_add_u32 v62, v3, 15, s52
    v_lshl_add_u32 v62, v58, 4, v62
    s_and_b32 s57, s40, 3
    s_mul_i32 s57, s57, 2
    s_bfe_u32 s53, s40, 0x30002
    s_and_b32 s53, s53, 3
    s_mul_i32 s53, s53, 8
    s_add_u32 s57, s57, s53
    s_add_u32 s57, s57, 2
    s_cmp_eq_u32 s57, s43
    s_subb_u32 s57, s57, 0
    s_min_u32 s49, s57, s43
    s_max_u32 s53, s57, s43
    s_add_u32 s44, s44, s43
    s_cmp_gt_u32 s57, s43
    s_cselect_b32 s94, 1, 0
    s_cmp_eq_u32 s44, s43
    s_cselect_b32 s95, 0, 1
    s_sub_u32 s44, s44, s53
    s_sub_u32 s43, s53, s49
    s_mov_b32 s50, 0
    v_mov_b32 v20, 0
    v_mov_b32 v21, 0
    v_mov_b32 v22, 0
    v_mov_b32 v23, 0
    v_mov_b32 v24, 0
    v_mov_b32 v25, 0
    v_mov_b32 v26, 0
    v_mov_b32 v27, 0
    v_mov_b32 v38, 0xff800000
    v_mov_b32 v39, 0
    v_mov_b32 v28, 0
    v_mov_b32 v29, 0
    v_mov_b32 v30, 0
    v_mov_b32 v31, 0
    s_mov_b32 s76, 0
    s_add_u32 s78, s43, s44
    s_add_u32 s78, s78, s49
    s_lshl_b32 s78, s78, 1
    s_sub_u32 s78, s78, 3
    s_cmp_eq_u32 s41, 6
    s_cselect_b32 s52, 10, 0
    s_sub_u32 s78, s78, s52
    s_and_b32 s52, s40, 3
    s_cmp_eq_u32 s52, 1
    s_cselect_b32 s52, 8, 0
    s_sub_u32 s78, s78, s52
    s_mul_i32 s52, s3, 18944
    s_add_u32 s52, s52, 22528
    v_lshl_add_u32 v140, v2, 2, s52
    v_mov_b32 v141, v140
    s_add_u32 s58, s77, 0x18000
    s_and_b32 s58, s58, 0x3ffff
    buffer_load_dwordx4 a[48:51], v61, s[16:19], s58 offen
    s_waitcnt vmcnt(13)
    v_perm_b32 v224, v192, v192, v240
    v_perm_b32 v225, v192, v192, v241
    v_perm_b32 v226, v192, v192, v242
    v_perm_b32 v227, v192, v192, v243
    s_add_u32 s58, s77, 0x1a000
    s_and_b32 s58, s58, 0x3ffff
    buffer_load_dwordx4 a[52:55], v61, s[16:19], s58 offen
    s_waitcnt vmcnt(13)
    v_perm_b32 v228, v192, v192, v244
    v_perm_b32 v229, v192, v192, v245
    v_perm_b32 v230, v192, v192, v246
    v_perm_b32 v231, v192, v192, v247
    v_mfma_f32_16x16x32_bf16 v[28:31], v[224:227], a[0:3], v[28:31]
    s_add_u32 s58, s77, 0x1c000
    s_and_b32 s58, s58, 0x3ffff
    buffer_load_dwordx4 a[56:59], v61, s[16:19], s58 offen
    s_waitcnt vmcnt(13)
    v_perm_b32 v232, v193, v193, v240
    v_perm_b32 v233, v193, v193, v241
    v_perm_b32 v234, v193, v193, v242
    v_perm_b32 v235, v193, v193, v243
    v_mfma_f32_16x16x32_bf16 v[28:31], v[228:231], a[4:7], v[28:31]
    s_add_u32 s58, s77, 0x1e000
    s_and_b32 s58, s58, 0x3ffff
    buffer_load_dwordx4 a[60:63], v61, s[16:19], s58 offen
    s_waitcnt vmcnt(13)
    v_perm_b32 v236, v193, v193, v244
    v_perm_b32 v237, v193, v193, v245
    v_perm_b32 v238, v193, v193, v246
    v_perm_b32 v239, v193, v193, v247
    v_mfma_f32_16x16x32_bf16 v[28:31], v[232:235], a[8:11], v[28:31]
    s_add_u32 s58, s77, 0x20000
    s_and_b32 s58, s58, 0x3ffff
    buffer_load_dwordx4 a[64:67], v61, s[16:19], s58 offen
    s_waitcnt vmcnt(13)
    v_perm_b32 v224, v194, v194, v240
    v_perm_b32 v225, v194, v194, v241
    v_perm_b32 v226, v194, v194, v242
    v_perm_b32 v227, v194, v194, v243
    v_mfma_f32_16x16x32_bf16 v[28:31], v[236:239], a[12:15], v[28:31]
    s_add_u32 s58, s77, 0x22000
    s_and_b32 s58, s58, 0x3ffff
    buffer_load_dwordx4 a[68:71], v61, s[16:19], s58 offen
    s_waitcnt vmcnt(13)
    v_perm_b32 v228, v194, v194, v244
    v_perm_b32 v229, v194, v194, v245
    v_perm_b32 v230, v194, v194, v246
    v_perm_b32 v231, v194, v194, v247
    v_mfma_f32_16x16x32_bf16 v[28:31], v[224:227], a[16:19], v[28:31]
    s_add_u32 s58, s77, 0x24000
    s_and_b32 s58, s58, 0x3ffff
    buffer_load_dwordx4 a[72:75], v61, s[16:19], s58 offen
    s_waitcnt vmcnt(13)
    v_perm_b32 v232, v195, v195, v240
    v_perm_b32 v233, v195, v195, v241
    v_perm_b32 v234, v195, v195, v242
    v_perm_b32 v235, v195, v195, v243
    v_mfma_f32_16x16x32_bf16 v[28:31], v[228:231], a[20:23], v[28:31]
    s_add_u32 s58, s77, 0x26000
    s_and_b32 s58, s58, 0x3ffff
    buffer_load_dwordx4 a[76:79], v61, s[16:19], s58 offen
    s_waitcnt vmcnt(13)
    v_perm_b32 v236, v195, v195, v244
    v_perm_b32 v237, v195, v195, v245
    v_perm_b32 v238, v195, v195, v246
    v_perm_b32 v239, v195, v195, v247
    v_mfma_f32_16x16x32_bf16 v[28:31], v[232:235], a[24:27], v[28:31]
    s_add_u32 s58, s77, 0x28000
    s_and_b32 s58, s58, 0x3ffff
    buffer_load_dwordx4 a[80:83], v61, s[16:19], s58 offen
    s_waitcnt vmcnt(13)
    v_perm_b32 v224, v196, v196, v240
    v_perm_b32 v225, v196, v196, v241
    v_perm_b32 v226, v196, v196, v242
    v_perm_b32 v227, v196, v196, v243
    v_mfma_f32_16x16x32_bf16 v[28:31], v[236:239], a[28:31], v[28:31]
    s_add_u32 s58, s77, 0x2a000
    s_and_b32 s58, s58, 0x3ffff
    buffer_load_dwordx4 a[84:87], v61, s[16:19], s58 offen
    s_waitcnt vmcnt(13)
    v_perm_b32 v228, v196, v196, v244
    v_perm_b32 v229, v196, v196, v245
    v_perm_b32 v230, v196, v196, v246
    v_perm_b32 v231, v196, v196, v247
    v_mfma_f32_16x16x32_bf16 v[28:31], v[224:227], a[32:35], v[28:31]
    s_add_u32 s58, s77, 0x2c000
    s_and_b32 s58, s58, 0x3ffff
    buffer_load_dwordx4 a[88:91], v61, s[16:19], s58 offen
    s_waitcnt vmcnt(13)
    v_perm_b32 v232, v197, v197, v240
    v_perm_b32 v233, v197, v197, v241
    v_perm_b32 v234, v197, v197, v242
    v_perm_b32 v235, v197, v197, v243
    v_mfma_f32_16x16x32_bf16 v[28:31], v[228:231], a[36:39], v[28:31]
    s_add_u32 s58, s77, 0x2e000
    s_and_b32 s58, s58, 0x3ffff
    buffer_load_dwordx4 a[92:95], v61, s[16:19], s58 offen
    s_waitcnt vmcnt(13)
    v_perm_b32 v236, v197, v197, v244
    v_perm_b32 v237, v197, v197, v245
    v_perm_b32 v238, v197, v197, v246
    v_perm_b32 v239, v197, v197, v247
    v_mfma_f32_16x16x32_bf16 v[28:31], v[232:235], a[40:43], v[28:31]
    s_add_u32 s58, s77, 0x30000
    s_and_b32 s58, s58, 0x3ffff
    buffer_load_dwordx4 a[96:99], v61, s[16:19], s58 offen
    s_waitcnt vmcnt(13)
    v_perm_b32 v224, v198, v198, v240
    v_perm_b32 v225, v198, v198, v241
    v_perm_b32 v226, v198, v198, v242
    v_perm_b32 v227, v198, v198, v243
    v_mfma_f32_16x16x32_bf16 v[28:31], v[236:239], a[44:47], v[28:31]
    s_add_u32 s58, s77, 0x32000
    s_and_b32 s58, s58, 0x3ffff
    buffer_load_dwordx4 a[100:103], v61, s[16:19], s58 offen
    s_waitcnt vmcnt(13)
    v_perm_b32 v228, v198, v198, v244
    v_perm_b32 v229, v198, v198, v245
    v_perm_b32 v230, v198, v198, v246
    v_perm_b32 v231, v198, v198, v247
    v_mfma_f32_16x16x32_bf16 v[28:31], v[224:227], a[48:51], v[28:31]
    s_add_u32 s58, s77, 0x34000
    s_and_b32 s58, s58, 0x3ffff
    buffer_load_dwordx4 a[104:107], v61, s[16:19], s58 offen
    buffer_load_dwordx4 v[64:67], v1, s[8:11], s45 offen offset:0 nt
    s_waitcnt vmcnt(14)
    v_perm_b32 v232, v199, v199, v240
    v_perm_b32 v233, v199, v199, v241
    v_perm_b32 v234, v199, v199, v242
    v_perm_b32 v235, v199, v199, v243
    v_mfma_f32_16x16x32_bf16 v[28:31], v[228:231], a[52:55], v[28:31]
    s_add_u32 s58, s77, 0x36000
    s_and_b32 s58, s58, 0x3ffff
    buffer_load_dwordx4 a[108:111], v61, s[16:19], s58 offen
    s_waitcnt vmcnt(14)
    v_perm_b32 v236, v199, v199, v244
    v_perm_b32 v237, v199, v199, v245
    v_perm_b32 v238, v199, v199, v246
    v_perm_b32 v239, v199, v199, v247
    v_mfma_f32_16x16x32_bf16 v[28:31], v[232:235], a[56:59], v[28:31]
    s_add_u32 s58, s77, 0x38000
    s_and_b32 s58, s58, 0x3ffff
    buffer_load_dwordx4 a[112:115], v61, s[16:19], s58 offen
    s_waitcnt vmcnt(14)
    v_perm_b32 v224, v200, v200, v240
    v_perm_b32 v225, v200, v200, v241
    v_perm_b32 v226, v200, v200, v242
    v_perm_b32 v227, v200, v200, v243
    v_mfma_f32_16x16x32_bf16 v[28:31], v[236:239], a[60:63], v[28:31]
    s_add_u32 s58, s77, 0x3a000
    s_and_b32 s58, s58, 0x3ffff
    buffer_load_dwordx4 a[116:119], v61, s[16:19], s58 offen
    buffer_load_dwordx4 v[68:71], v1, s[8:11], s45 offen offset:1024 nt
    s_waitcnt vmcnt(15)
    v_perm_b32 v228, v200, v200, v244
    v_perm_b32 v229, v200, v200, v245
    v_perm_b32 v230, v200, v200, v246
    v_perm_b32 v231, v200, v200, v247
    v_mfma_f32_16x16x32_bf16 v[28:31], v[224:227], a[64:67], v[28:31]
    s_add_u32 s58, s77, 0x3c000
    s_and_b32 s58, s58, 0x3ffff
    buffer_load_dwordx4 a[120:123], v61, s[16:19], s58 offen
    s_waitcnt vmcnt(15)
    v_perm_b32 v232, v201, v201, v240
    v_perm_b32 v233, v201, v201, v241
    v_perm_b32 v234, v201, v201, v242
    v_perm_b32 v235, v201, v201, v243
    v_mfma_f32_16x16x32_bf16 v[28:31], v[228:231], a[68:71], v[28:31]
    s_add_u32 s58, s77, 0x3e000
    s_and_b32 s58, s58, 0x3ffff
    buffer_load_dwordx4 a[124:127], v61, s[16:19], s58 offen
    buffer_load_dwordx4 v[72:75], v1, s[8:11], s45 offen offset:2048 nt
    s_waitcnt vmcnt(16)
    v_perm_b32 v236, v201, v201, v244
    v_perm_b32 v237, v201, v201, v245
    v_perm_b32 v238, v201, v201, v246
    v_perm_b32 v239, v201, v201, v247
    v_mfma_f32_16x16x32_bf16 v[28:31], v[232:235], a[72:75], v[28:31]
    s_waitcnt vmcnt(15)
    v_perm_b32 v224, v202, v202, v240
    v_perm_b32 v225, v202, v202, v241
    v_perm_b32 v226, v202, v202, v242
    v_perm_b32 v227, v202, v202, v243
    v_mfma_f32_16x16x32_bf16 v[28:31], v[236:239], a[76:79], v[28:31]
    s_waitcnt vmcnt(14)
    v_perm_b32 v228, v202, v202, v244
    v_perm_b32 v229, v202, v202, v245
    v_perm_b32 v230, v202, v202, v246
    v_perm_b32 v231, v202, v202, v247
    v_mfma_f32_16x16x32_bf16 v[28:31], v[224:227], a[80:83], v[28:31]
    buffer_load_dwordx4 v[76:79], v1, s[8:11], s45 offen offset:3072 nt
    s_add_u32 s45, s45, 0x4000
    s_cmp_eq_u32 s45, s46
    s_cselect_b32 s45, s47, s45
    s_cmp_eq_u32 s45, s48
    s_cselect_b32 s45, s97, s45
    s_cselect_b32 s8, s26, s8
    s_cselect_b32 s9, s27, s9
    s_cselect_b32 s10, s96, s10
    s_cselect_b32 s96, 0, s96
    s_waitcnt vmcnt(14)
    v_perm_b32 v232, v203, v203, v240
    v_perm_b32 v233, v203, v203, v241
    v_perm_b32 v234, v203, v203, v242
    v_perm_b32 v235, v203, v203, v243
    v_mfma_f32_16x16x32_bf16 v[28:31], v[228:231], a[84:87], v[28:31]
    s_waitcnt vmcnt(13)
    v_perm_b32 v236, v203, v203, v244
    v_perm_b32 v237, v203, v203, v245
    v_perm_b32 v238, v203, v203, v246
    v_perm_b32 v239, v203, v203, v247
    v_mfma_f32_16x16x32_bf16 v[28:31], v[232:235], a[88:91], v[28:31]
    s_waitcnt vmcnt(12)
    v_perm_b32 v224, v204, v204, v240
    v_perm_b32 v225, v204, v204, v241
    v_perm_b32 v226, v204, v204, v242
    v_perm_b32 v227, v204, v204, v243
    v_mfma_f32_16x16x32_bf16 v[28:31], v[236:239], a[92:95], v[28:31]
    buffer_load_dwordx4 v[80:83], v1, s[8:11], s45 offen offset:0 nt
    s_waitcnt vmcnt(12)
    v_perm_b32 v228, v204, v204, v244
    v_perm_b32 v229, v204, v204, v245
    v_perm_b32 v230, v204, v204, v246
    v_perm_b32 v231, v204, v204, v247
    v_mfma_f32_16x16x32_bf16 v[28:31], v[224:227], a[96:99], v[28:31]
    s_waitcnt vmcnt(11)
    v_perm_b32 v232, v205, v205, v240
    v_perm_b32 v233, v205, v205, v241
    v_perm_b32 v234, v205, v205, v242
    v_perm_b32 v235, v205, v205, v243
    v_mfma_f32_16x16x32_bf16 v[28:31], v[228:231], a[100:103], v[28:31]
    buffer_load_dwordx4 v[84:87], v1, s[8:11], s45 offen offset:1024 nt
    s_waitcnt vmcnt(11)
    v_perm_b32 v236, v205, v205, v244
    v_perm_b32 v237, v205, v205, v245
    v_perm_b32 v238, v205, v205, v246
    v_perm_b32 v239, v205, v205, v247
    v_mfma_f32_16x16x32_bf16 v[28:31], v[232:235], a[104:107], v[28:31]
    s_waitcnt vmcnt(9)
    v_perm_b32 v224, v206, v206, v240
    v_perm_b32 v225, v206, v206, v241
    v_perm_b32 v226, v206, v206, v242
    v_perm_b32 v227, v206, v206, v243
    v_mfma_f32_16x16x32_bf16 v[28:31], v[236:239], a[108:111], v[28:31]
    s_waitcnt vmcnt(8)
    v_perm_b32 v228, v206, v206, v244
    v_perm_b32 v229, v206, v206, v245
    v_perm_b32 v230, v206, v206, v246
    v_perm_b32 v231, v206, v206, v247
    v_mfma_f32_16x16x32_bf16 v[28:31], v[224:227], a[112:115], v[28:31]
    buffer_load_dwordx4 v[88:91], v1, s[8:11], s45 offen offset:2048 nt
    s_waitcnt vmcnt(8)
    v_perm_b32 v232, v207, v207, v240
    v_perm_b32 v233, v207, v207, v241
    v_perm_b32 v234, v207, v207, v242
    v_perm_b32 v235, v207, v207, v243
    v_mfma_f32_16x16x32_bf16 v[28:31], v[228:231], a[116:119], v[28:31]
    s_waitcnt vmcnt(6)
    v_perm_b32 v236, v207, v207, v244
    v_perm_b32 v237, v207, v207, v245
    v_perm_b32 v238, v207, v207, v246
    v_perm_b32 v239, v207, v207, v247
    v_mfma_f32_16x16x32_bf16 v[28:31], v[232:235], a[120:123], v[28:31]
    buffer_load_dwordx4 v[92:95], v1, s[8:11], s45 offen offset:3072 nt
    s_add_u32 s45, s45, 0x4000
    s_cmp_eq_u32 s45, s46
    s_cselect_b32 s45, s47, s45
    s_cmp_eq_u32 s45, s48
    s_cselect_b32 s45, s97, s45
    s_cselect_b32 s8, s26, s8
    s_cselect_b32 s9, s27, s9
    s_cselect_b32 s10, s96, s10
    s_cselect_b32 s96, 0, s96
    buffer_load_dwordx4 v[96:99], v1, s[8:11], s45 offen offset:0 nt
    buffer_load_dwordx4 v[100:103], v1, s[8:11], s45 offen offset:1024 nt
    buffer_load_dwordx4 v[104:107], v1, s[8:11], s45 offen offset:2048 nt
    buffer_load_dwordx4 v[108:111], v1, s[8:11], s45 offen offset:3072 nt
    s_add_u32 s45, s45, 0x4000
    s_cmp_eq_u32 s45, s46
    s_cselect_b32 s45, s47, s45
    s_cmp_eq_u32 s45, s48
    s_cselect_b32 s45, s97, s45
    s_cselect_b32 s8, s26, s8
    s_cselect_b32 s9, s27, s9
    s_cselect_b32 s10, s96, s10
    s_cselect_b32 s96, 0, s96
    s_waitcnt vmcnt(10)
    s_nop 1
    v_mfma_f32_16x16x32_bf16 v[28:31], v[236:239], a[124:127], v[28:31]
    s_lshl_b32 s52, s3, 10
    v_lshrrev_b32 v47, 1, v3
    v_lshl_add_u32 v47, v47, 9, s52
    v_lshl_add_u32 v47, v58, 5, v47
    v_and_b32 v48, 1, v3
    v_lshl_add_u32 v47, v48, 4, v47
    v_lshlrev_b32 v48, 5, v58
    s_nop 2
    ds_write_b128 v47, v[28:31] offset:0
    s_waitcnt lgkmcnt(0)
    s_barrier
    ds_read_b128 v[192:195], v48 offset:0
    ds_read_b128 v[196:199], v48 offset:16
    ds_read_b128 v[200:203], v48 offset:1024
    ds_read_b128 v[204:207], v48 offset:1040
    ds_read_b128 v[208:211], v48 offset:2048
    ds_read_b128 v[212:215], v48 offset:2064
    ds_read_b128 v[216:219], v48 offset:3072
    ds_read_b128 v[220:223], v48 offset:3088
    s_waitcnt lgkmcnt(4)
    v_add_f32 v192, v192, v200
    v_add_f32 v193, v193, v201
    v_add_f32 v194, v194, v202
    v_add_f32 v195, v195, v203
    v_add_f32 v196, v196, v204
    v_add_f32 v197, v197, v205
    v_add_f32 v198, v198, v206
    v_add_f32 v199, v199, v207
    s_waitcnt lgkmcnt(0)
    v_add_f32 v208, v208, v216
    v_add_f32 v209, v209, v217
    v_add_f32 v210, v210, v218
    v_add_f32 v211, v211, v219
    v_add_f32 v212, v212, v220
    v_add_f32 v213, v213, v221
    v_add_f32 v214, v214, v222
    v_add_f32 v215, v215, v223
    v_add_f32 v192, v192, v208
    v_add_f32 v193, v193, v209
    v_add_f32 v194, v194, v210
    v_add_f32 v195, v195, v211
    v_add_f32 v196, v196, v212
    v_add_f32 v197, v197, v213
    v_add_f32 v198, v198, v214
    v_add_f32 v199, v199, v215
    v_cvt_pk_bf16_f32 v4, v192, v193
    v_cvt_pk_bf16_f32 v5, v194, v195
    v_cvt_pk_bf16_f32 v6, v196, v197
    v_cvt_pk_bf16_f32 v7, v198, v199
    v_mov_b32 v28, 0
    v_mov_b32 v29, 0
    v_mov_b32 v30, 0
    v_mov_b32 v31, 0
    v_mov_b32 v32, 0
    v_mov_b32 v33, 0
    v_mov_b32 v34, 0
    v_mov_b32 v35, 0
    v_mov_b32 v36, 0xff800000
    v_mov_b32 v37, 0
    s_mov_b32 s16, s30
    s_mov_b32 s17, s31
    s_mov_b32 s18, 0x400000
    s_mov_b32 s19, 0x20000
    s_lshr_b32 s77, s77, 3
B_K_0:
    s_waitcnt vmcnt(8)
    v_dot2_f32_bf16 v40, v64, v4, 0
    v_dot2_f32_bf16 v41, v68, v4, 0
    v_dot2_f32_bf16 v42, v72, v4, 0
    v_dot2_f32_bf16 v43, v76, v4, 0
    v_dot2_f32_bf16 v40, v65, v5, v40
    v_dot2_f32_bf16 v41, v69, v5, v41
    v_dot2_f32_bf16 v42, v73, v5, v42
    v_dot2_f32_bf16 v43, v77, v5, v43
    v_dot2_f32_bf16 v40, v66, v6, v40
    v_dot2_f32_bf16 v41, v70, v6, v41
    v_dot2_f32_bf16 v42, v74, v6, v42
    v_dot2_f32_bf16 v43, v78, v6, v43
    v_dot2_f32_bf16 v40, v67, v7, v40
    v_dot2_f32_bf16 v41, v71, v7, v41
    v_dot2_f32_bf16 v42, v75, v7, v42
    v_dot2_f32_bf16 v43, v79, v7, v43
    s_sub_u32 s100, s100, 1
    s_cmp_ge_i32 s100, 0
    s_cbranch_scc1 B_CK_0_F
    s_waitcnt vmcnt(5)
    buffer_load_dwordx4 v[64:67], v1, s[8:11], s45 offen offset:0 nt
    s_waitcnt vmcnt(5)
    buffer_load_dwordx4 v[68:71], v1, s[8:11], s45 offen offset:1024 nt
    s_waitcnt vmcnt(5)
    buffer_load_dwordx4 v[72:75], v1, s[8:11], s45 offen offset:2048 nt
    s_waitcnt vmcnt(5)
    buffer_load_dwordx4 v[76:79], v1, s[8:11], s45 offen offset:3072 nt
    s_branch B_CK_0_E
B_CK_0_F:
    buffer_load_dwordx4 v[64:67], v1, s[8:11], s45 offen offset:0 nt
    buffer_load_dwordx4 v[68:71], v1, s[8:11], s45 offen offset:1024 nt
    buffer_load_dwordx4 v[72:75], v1, s[8:11], s45 offen offset:2048 nt
    buffer_load_dwordx4 v[76:79], v1, s[8:11], s45 offen offset:3072 nt
B_CK_0_E:
    s_sub_u32 s78, s78, 1
    s_add_u32 s45, s45, 0x4000
    s_cmp_eq_u32 s45, s46
    s_cselect_b32 s45, s47, s45
    s_cmp_eq_u32 s45, s48
    s_cselect_b32 s45, s97, s45
    s_cselect_b32 s8, s26, s8
    s_cselect_b32 s9, s27, s9
    s_cselect_b32 s10, s96, s10
    s_cselect_b32 s96, 0, s96
    v_add_f32_dpp v44, v40, v40 row_ror:8 row_mask:0xf bank_mask:0x3
    v_add_f32_dpp v45, v41, v41 row_ror:8 row_mask:0xf bank_mask:0x3
    v_add_f32_dpp v44, v42, v42 row_ror:8 row_mask:0xf bank_mask:0xc
    v_add_f32_dpp v45, v43, v43 row_ror:8 row_mask:0xf bank_mask:0xc
    s_nop 1
    v_add_f32_dpp v46, v44, v44 row_shl:4 row_mask:0xf bank_mask:0x5
    v_add_f32_dpp v46, v45, v45 row_shr:4 row_mask:0xf bank_mask:0xa
    s_nop 1
    v_add_f32_dpp v46, v46, v46 quad_perm:[2,3,0,1] row_mask:0xf bank_mask:0xf
    s_nop 1
    v_add_f32_dpp v46, v46, v46 quad_perm:[1,0,3,2] row_mask:0xf bank_mask:0xf
    v_cvt_pk_bf16_f32 v46, v46, v46
    v_and_b32 v46, s56, v46
    v_mul_f32 v46, s55, v46
    v_cvt_pk_bf16_f32 v46, v46, v46
    v_and_b32 v46, s56, v46
    ds_write_b32 v140, v46
    v_max_f32 v38, v38, v46
    v_add_u32 v140, 0x100, v140
    s_mov_b32 s51, 1
    s_sub_u32 s49, s49, 1
    s_cmp_eq_u32 s49, 0
    s_cbranch_scc1 B_KEVENT
B_K_1:
    s_waitcnt vmcnt(8)
    v_dot2_f32_bf16 v40, v80, v4, 0
    v_dot2_f32_bf16 v41, v84, v4, 0
    v_dot2_f32_bf16 v42, v88, v4, 0
    v_dot2_f32_bf16 v43, v92, v4, 0
    v_dot2_f32_bf16 v40, v81, v5, v40
    v_dot2_f32_bf16 v41, v85, v5, v41
    v_dot2_f32_bf16 v42, v89, v5, v42
    v_dot2_f32_bf16 v43, v93, v5, v43
    v_dot2_f32_bf16 v40, v82, v6, v40
    v_dot2_f32_bf16 v41, v86, v6, v41
    v_dot2_f32_bf16 v42, v90, v6, v42
    v_dot2_f32_bf16 v43, v94, v6, v43
    v_dot2_f32_bf16 v40, v83, v7, v40
    v_dot2_f32_bf16 v41, v87, v7, v41
    v_dot2_f32_bf16 v42, v91, v7, v42
    v_dot2_f32_bf16 v43, v95, v7, v43
    s_sub_u32 s100, s100, 1
    s_cmp_ge_i32 s100, 0
    s_cbranch_scc1 B_CK_1_F
    s_waitcnt vmcnt(5)
    buffer_load_dwordx4 v[80:83], v1, s[8:11], s45 offen offset:0 nt
    s_waitcnt vmcnt(5)
    buffer_load_dwordx4 v[84:87], v1, s[8:11], s45 offen offset:1024 nt
    s_waitcnt vmcnt(5)
    buffer_load_dwordx4 v[88:91], v1, s[8:11], s45 offen offset:2048 nt
    s_waitcnt vmcnt(5)
    buffer_load_dwordx4 v[92:95], v1, s[8:11], s45 offen offset:3072 nt
    s_branch B_CK_1_E
B_CK_1_F:
    buffer_load_dwordx4 v[80:83], v1, s[8:11], s45 offen offset:0 nt
    buffer_load_dwordx4 v[84:87], v1, s[8:11], s45 offen offset:1024 nt
    buffer_load_dwordx4 v[88:91], v1, s[8:11], s45 offen offset:2048 nt
    buffer_load_dwordx4 v[92:95], v1, s[8:11], s45 offen offset:3072 nt
B_CK_1_E:
    s_sub_u32 s78, s78, 1
    s_add_u32 s45, s45, 0x4000
    s_cmp_eq_u32 s45, s46
    s_cselect_b32 s45, s47, s45
    s_cmp_eq_u32 s45, s48
    s_cselect_b32 s45, s97, s45
    s_cselect_b32 s8, s26, s8
    s_cselect_b32 s9, s27, s9
    s_cselect_b32 s10, s96, s10
    s_cselect_b32 s96, 0, s96
    v_add_f32_dpp v44, v40, v40 row_ror:8 row_mask:0xf bank_mask:0x3
    v_add_f32_dpp v45, v41, v41 row_ror:8 row_mask:0xf bank_mask:0x3
    v_add_f32_dpp v44, v42, v42 row_ror:8 row_mask:0xf bank_mask:0xc
    v_add_f32_dpp v45, v43, v43 row_ror:8 row_mask:0xf bank_mask:0xc
    s_nop 1
    v_add_f32_dpp v46, v44, v44 row_shl:4 row_mask:0xf bank_mask:0x5
    v_add_f32_dpp v46, v45, v45 row_shr:4 row_mask:0xf bank_mask:0xa
    s_nop 1
    v_add_f32_dpp v46, v46, v46 quad_perm:[2,3,0,1] row_mask:0xf bank_mask:0xf
    s_nop 1
    v_add_f32_dpp v46, v46, v46 quad_perm:[1,0,3,2] row_mask:0xf bank_mask:0xf
    v_cvt_pk_bf16_f32 v46, v46, v46
    v_and_b32 v46, s56, v46
    v_mul_f32 v46, s55, v46
    v_cvt_pk_bf16_f32 v46, v46, v46
    v_and_b32 v46, s56, v46
    ds_write_b32 v140, v46
    v_max_f32 v38, v38, v46
    v_add_u32 v140, 0x100, v140
    s_mov_b32 s51, 2
    s_sub_u32 s49, s49, 1
    s_cmp_eq_u32 s49, 0
    s_cbranch_scc1 B_KEVENT
B_K_2:
    s_waitcnt vmcnt(8)
    v_dot2_f32_bf16 v40, v96, v4, 0
    v_dot2_f32_bf16 v41, v100, v4, 0
    v_dot2_f32_bf16 v42, v104, v4, 0
    v_dot2_f32_bf16 v43, v108, v4, 0
    v_dot2_f32_bf16 v40, v97, v5, v40
    v_dot2_f32_bf16 v41, v101, v5, v41
    v_dot2_f32_bf16 v42, v105, v5, v42
    v_dot2_f32_bf16 v43, v109, v5, v43
    v_dot2_f32_bf16 v40, v98, v6, v40
    v_dot2_f32_bf16 v41, v102, v6, v41
    v_dot2_f32_bf16 v42, v106, v6, v42
    v_dot2_f32_bf16 v43, v110, v6, v43
    v_dot2_f32_bf16 v40, v99, v7, v40
    v_dot2_f32_bf16 v41, v103, v7, v41
    v_dot2_f32_bf16 v42, v107, v7, v42
    v_dot2_f32_bf16 v43, v111, v7, v43
    s_sub_u32 s100, s100, 1
    s_cmp_ge_i32 s100, 0
    s_cbranch_scc1 B_CK_2_F
    s_waitcnt vmcnt(5)
    buffer_load_dwordx4 v[96:99], v1, s[8:11], s45 offen offset:0 nt
    s_waitcnt vmcnt(5)
    buffer_load_dwordx4 v[100:103], v1, s[8:11], s45 offen offset:1024 nt
    s_waitcnt vmcnt(5)
    buffer_load_dwordx4 v[104:107], v1, s[8:11], s45 offen offset:2048 nt
    s_waitcnt vmcnt(5)
    buffer_load_dwordx4 v[108:111], v1, s[8:11], s45 offen offset:3072 nt
    s_branch B_CK_2_E
B_CK_2_F:
    buffer_load_dwordx4 v[96:99], v1, s[8:11], s45 offen offset:0 nt
    buffer_load_dwordx4 v[100:103], v1, s[8:11], s45 offen offset:1024 nt
    buffer_load_dwordx4 v[104:107], v1, s[8:11], s45 offen offset:2048 nt
    buffer_load_dwordx4 v[108:111], v1, s[8:11], s45 offen offset:3072 nt
B_CK_2_E:
    s_sub_u32 s78, s78, 1
    s_add_u32 s45, s45, 0x4000
    s_cmp_eq_u32 s45, s46
    s_cselect_b32 s45, s47, s45
    s_cmp_eq_u32 s45, s48
    s_cselect_b32 s45, s97, s45
    s_cselect_b32 s8, s26, s8
    s_cselect_b32 s9, s27, s9
    s_cselect_b32 s10, s96, s10
    s_cselect_b32 s96, 0, s96
    v_add_f32_dpp v44, v40, v40 row_ror:8 row_mask:0xf bank_mask:0x3
    v_add_f32_dpp v45, v41, v41 row_ror:8 row_mask:0xf bank_mask:0x3
    v_add_f32_dpp v44, v42, v42 row_ror:8 row_mask:0xf bank_mask:0xc
    v_add_f32_dpp v45, v43, v43 row_ror:8 row_mask:0xf bank_mask:0xc
    s_nop 1
    v_add_f32_dpp v46, v44, v44 row_shl:4 row_mask:0xf bank_mask:0x5
    v_add_f32_dpp v46, v45, v45 row_shr:4 row_mask:0xf bank_mask:0xa
    s_nop 1
    v_add_f32_dpp v46, v46, v46 quad_perm:[2,3,0,1] row_mask:0xf bank_mask:0xf
    s_nop 1
    v_add_f32_dpp v46, v46, v46 quad_perm:[1,0,3,2] row_mask:0xf bank_mask:0xf
    v_cvt_pk_bf16_f32 v46, v46, v46
    v_and_b32 v46, s56, v46
    v_mul_f32 v46, s55, v46
    v_cvt_pk_bf16_f32 v46, v46, v46
    v_and_b32 v46, s56, v46
    ds_write_b32 v140, v46
    v_max_f32 v38, v38, v46
    v_add_u32 v140, 0x100, v140
    s_mov_b32 s51, 0
    s_sub_u32 s49, s49, 1
    s_cmp_eq_u32 s49, 0
    s_cbranch_scc1 B_KEVENT
    s_branch B_K_0
B_KEVENT:
    s_cmp_eq_u32 s50, 2
    s_cbranch_scc1 B_KEND
    s_cmp_eq_u32 s50, s94
    s_cbranch_scc0 B_KEV1
    s_load_dword s76, s[32:33], 0
    s_mov_b32 s100, 4
    s_add_u32 s58, s77, 0x0
    s_and_b32 s58, s58, 0x7fff
    buffer_load_dwordx4 a[0:3], v62, s[16:19], s58 offen offset:0
    buffer_load_dwordx4 a[4:7], v62, s[16:19], s58 offen offset:1024
    buffer_load_dwordx4 a[8:11], v62, s[16:19], s58 offen offset:2048
    buffer_load_dwordx4 a[12:15], v62, s[16:19], s58 offen offset:3072
    s_add_u32 s58, s77, 0x1000
    s_and_b32 s58, s58, 0x7fff
    buffer_load_dwordx4 a[16:19], v62, s[16:19], s58 offen offset:0
    buffer_load_dwordx4 a[20:23], v62, s[16:19], s58 offen offset:1024
    buffer_load_dwordx4 a[24:27], v62, s[16:19], s58 offen offset:2048
    buffer_load_dwordx4 a[28:31], v62, s[16:19], s58 offen offset:3072
    s_add_u32 s58, s77, 0x2000
    s_and_b32 s58, s58, 0x7fff
    buffer_load_dwordx4 a[32:35], v62, s[16:19], s58 offen offset:0
    buffer_load_dwordx4 a[36:39], v62, s[16:19], s58 offen offset:1024
    buffer_load_dwordx4 a[40:43], v62, s[16:19], s58 offen offset:2048
    buffer_load_dwordx4 a[44:47], v62, s[16:19], s58 offen offset:3072
    s_add_u32 s58, s77, 0x3000
    s_and_b32 s58, s58, 0x7fff
    buffer_load_dwordx4 a[48:51], v62, s[16:19], s58 offen offset:0
    buffer_load_dwordx4 a[52:55], v62, s[16:19], s58 offen offset:1024
    buffer_load_dwordx4 a[56:59], v62, s[16:19], s58 offen offset:2048
    buffer_load_dwordx4 a[60:63], v62, s[16:19], s58 offen offset:3072
    s_add_u32 s58, s77, 0x4000
    s_and_b32 s58, s58, 0x7fff
    buffer_load_dwordx4 a[64:67], v62, s[16:19], s58 offen offset:0
    buffer_load_dwordx4 a[68:71], v62, s[16:19], s58 offen offset:1024
    buffer_load_dwordx4 a[72:75], v62, s[16:19], s58 offen offset:2048
    buffer_load_dwordx4 a[76:79], v62, s[16:19], s58 offen offset:3072
    s_add_u32 s58, s77, 0x5000
    s_and_b32 s58, s58, 0x7fff
    buffer_load_dwordx4 a[80:83], v62, s[16:19], s58 offen offset:0
    buffer_load_dwordx4 a[84:87], v62, s[16:19], s58 offen offset:1024
    buffer_load_dwordx4 a[88:91], v62, s[16:19], s58 offen offset:2048
    buffer_load_dwordx4 a[92:95], v62, s[16:19], s58 offen offset:3072
    s_add_u32 s58, s77, 0x6000
    s_and_b32 s58, s58, 0x7fff
    buffer_load_dwordx4 a[96:99], v62, s[16:19], s58 offen offset:0
    buffer_load_dwordx4 a[100:103], v62, s[16:19], s58 offen offset:1024
    buffer_load_dwordx4 a[104:107], v62, s[16:19], s58 offen offset:2048
    buffer_load_dwordx4 a[108:111], v62, s[16:19], s58 offen offset:3072
    s_add_u32 s58, s77, 0x7000
    s_and_b32 s58, s58, 0x7fff
    buffer_load_dwordx4 a[112:115], v62, s[16:19], s58 offen offset:0
    buffer_load_dwordx4 a[116:119], v62, s[16:19], s58 offen offset:1024
    buffer_load_dwordx4 a[120:123], v62, s[16:19], s58 offen offset:2048
    buffer_load_dwordx4 a[124:127], v62, s[16:19], s58 offen offset:3072
    s_lshl_b32 s52, s3, 2
    v_add_u32 v128, s52, v3
    v_lshlrev_b32 v129, 2, v128
    v_lshlrev_b32 v128, 9, v128
    v_lshl_add_u32 v128, v58, 5, v128
    v_mov_b32 v130, s52
    v_lshrrev_b32 v47, 7, v0
    v_and_b32 v48, 127, v0
    v_lshlrev_b32 v131, 13, v47
    v_lshl_add_u32 v131, v48, 2, v131
    v_lshlrev_b32 v132, 4, v47
    v_lshlrev_b32 v133, 1, v0
    v_bfe_u32 v47, v0, 3, 1
    v_lshlrev_b32 v47, 8, v47
    v_lshl_add_u32 v47, v3, 6, v47
    s_lshr_b32 s52, s77, 9
    s_add_u32 s53, s52, 0
    s_and_b32 s53, s53, 63
    v_add_u32 v134, s53, v47
    s_add_u32 s53, s52, 16
    s_and_b32 s53, s53, 63
    v_add_u32 v135, s53, v47
    s_add_u32 s53, s52, 32
    s_and_b32 s53, s53, 63
    v_add_u32 v136, s53, v47
    s_add_u32 s53, s52, 48
    s_and_b32 s53, s53, 63
    v_add_u32 v137, s53, v47
    v_bfe_u32 v47, v0, 1, 1
    v_lshlrev_b32 v138, 4, v47
    v_lshlrev_b32 v139, 6, v47
    s_branch B_KNEXT
B_KEV1:
    s_cmp_eq_u32 s95, 0
    s_cbranch_scc1 B_KEND
    v_mov_b32 v36, v38
    v_mov_b32 v38, 0xff800000
    v_lshlrev_b32 v48, 5, v58
    s_waitcnt lgkmcnt(0)
    ds_read_b128 v[192:195], v48 offset:512
    ds_read_b128 v[196:199], v48 offset:528
    ds_read_b128 v[200:203], v48 offset:1536
    ds_read_b128 v[204:207], v48 offset:1552
    ds_read_b128 v[208:211], v48 offset:2560
    ds_read_b128 v[212:215], v48 offset:2576
    ds_read_b128 v[216:219], v48 offset:3584
    ds_read_b128 v[220:223], v48 offset:3600
    s_waitcnt lgkmcnt(4)
    v_add_f32 v192, v192, v200
    v_add_f32 v193, v193, v201
    v_add_f32 v194, v194, v202
    v_add_f32 v195, v195, v203
    v_add_f32 v196, v196, v204
    v_add_f32 v197, v197, v205
    v_add_f32 v198, v198, v206
    v_add_f32 v199, v199, v207
    s_waitcnt lgkmcnt(0)
    v_add_f32 v208, v208, v216
    v_add_f32 v209, v209, v217
    v_add_f32 v210, v210, v218
    v_add_f32 v211, v211, v219
    v_add_f32 v212, v212, v220
    v_add_f32 v213, v213, v221
    v_add_f32 v214, v214, v222
    v_add_f32 v215, v215, v223
    v_add_f32 v192, v192, v208
    v_add_f32 v193, v193, v209
    v_add_f32 v194, v194, v210
    v_add_f32 v195, v195, v211
    v_add_f32 v196, v196, v212
    v_add_f32 v197, v197, v213
    v_add_f32 v198, v198, v214
    v_add_f32 v199, v199, v215
    v_cvt_pk_bf16_f32 v4, v192, v193
    v_cvt_pk_bf16_f32 v5, v194, v195
    v_cvt_pk_bf16_f32 v6, v196, v197
    v_cvt_pk_bf16_f32 v7, v198, v199
B_KNEXT:
    s_add_u32 s50, s50, 1
    s_cmp_eq_u32 s50, 1
    s_cselect_b32 s49, s43, s44
    s_cmp_eq_u32 s51, 1
    s_cbranch_scc1 B_K_1
    s_cmp_eq_u32 s51, 2
    s_cbranch_scc1 B_K_2
    s_branch B_K_0
B_KEND:
    s_mov_b32 s20, s34
    s_mov_b32 s21, s35
    s_mov_b32 s22, 0x200000
    s_mov_b32 s23, 0x20000
    s_mov_b32 s36, s32
    s_mov_b32 s37, s33
    s_mov_b32 s38, 0x100
    s_mov_b32 s39, 0x20000
    s_lshl_b32 s52, s41, 2
    s_lshr_b32 s52, 0x1212110, s52
    s_and_b32 s57, s52, 15
    s_lshl_b32 s53, s42, 5
    s_add_u32 s53, s53, s40
    s_lshl_b32 s53, s53, 2
    s_add_u32 s52, s57, s53
    s_add_u32 s53, s53, 128
    s_cmp_eq_u32 s95, 0
    s_cselect_b32 s53, s52, s53
    s_cselect_b32 s52, 0x40000, s52
    v_mov_b32 v47, s52
    v_cmp_gt_u32 vcc, 2, v3
    v_mov_b32 v48, s53
    s_lshl_b32 s52, s3, 9
    v_cndmask_b32 v49, v48, v47, vcc
    v_lshl_add_u32 v49, v49, 11, s52
    v_lshl_add_u32 v49, v58, 5, v49
    v_and_b32 v47, 1, v3
    v_lshl_add_u32 v248, v47, 4, v49
    s_lshl_b32 s52, s42, 3
    s_lshl_b32 s53, s3, 1
    s_add_u32 s52, s52, s53
    s_lshl_b32 s52, s52, 5
    s_add_u32 s52, s52, s40
    s_lshl_b32 s52, s52, 5
    s_add_u32 s52, s52, 0x100000
    s_add_u32 s53, s52, 0x2000
    s_lshl_b32 s57, s57, 3
    s_add_u32 s52, s52, s57
    s_cmp_eq_u32 s95, 0
    s_cselect_b32 s53, s52, s53
    s_cselect_b32 s52, 0x300000, s52
    v_mov_b32 v47, s52
    v_cmp_gt_u32 vcc, 2, v2
    v_mov_b32 v48, s53
    v_and_b32 v59, 1, v2
    v_cndmask_b32 v49, v48, v47, vcc
    v_lshl_add_u32 v249, v59, 10, v49
    s_nop 0
    v_max_f32_dpp v36, v36, v36 row_ror:4 row_mask:0xf bank_mask:0xf
    v_max_f32_dpp v38, v38, v38 row_ror:4 row_mask:0xf bank_mask:0xf
    s_nop 0
    v_max_f32_dpp v36, v36, v36 row_ror:8 row_mask:0xf bank_mask:0xf
    v_max_f32_dpp v38, v38, v38 row_ror:8 row_mask:0xf bank_mask:0xf
    v_mov_b32 v47, v36
    s_nop 1
    v_permlane16_swap_b32 v36, v47
    s_nop 1
    v_max_f32 v36, v36, v47
    v_mov_b32 v47, v36
    s_nop 1
    v_permlane32_swap_b32 v36, v47
    s_nop 1
    v_max_f32 v36, v36, v47
    v_mov_b32 v47, v38
    s_nop 1
    v_permlane16_swap_b32 v38, v47
    s_nop 1
    v_max_f32 v38, v38, v47
    v_mov_b32 v47, v38
    s_nop 1
    v_permlane32_swap_b32 v38, v47
    s_nop 1
    v_max_f32 v38, v38, v47
    ds_write_b32 v130, v36 offset:20480
    ds_write_b32 v130, v38 offset:20496
    v_mov_b32 v47, 0
    s_waitcnt lgkmcnt(0)
    s_barrier
    ds_read_b128 v[40:43], v47 offset:20480
    ds_read_b128 v[52:55], v47 offset:20496
    ds_read_b32 v144, v141
    v_add_u32 v141, 0x100, v141
    v_bfe_u32 v47, v0, 1, 1
    s_waitcnt lgkmcnt(1)
    v_max3_f32 v142, v40, v41, v42
    v_max3_f32 v143, v52, v53, v54
    v_max_f32 v142, v142, v43
    v_max_f32 v143, v143, v55
    v_cmp_eq_u32 vcc, 0, v47
    v_mul_f32 v142, s54, v142
    v_mul_f32 v143, s54, v143
    s_cmp_eq_u32 s95, 0
    s_cselect_b64 s[60:61], 0, -1
    v_cndmask_b32 v196, v143, v142, vcc
    v_cndmask_b32 v38, v143, v142, s[60:61]
    s_mov_b32 s49, s98
    s_mov_b32 s50, s95
    s_cmp_eq_u32 s51, 1
    s_cbranch_scc1 B_V_1
    s_cmp_eq_u32 s51, 2
    s_cbranch_scc1 B_V_2
B_V_0:
    s_waitcnt lgkmcnt(0)
    v_fma_f32 v47, v144, s54, -v38
    ds_read_b32 v144, v141
    v_exp_f32 v47, v47
    v_add_u32 v141, 0x100, v141
    v_add_f32 v39, v39, v47
    v_cvt_pk_bf16_f32 v48, v47, v47
    v_and_b32 v50, v48, v12
    v_and_b32 v51, v48, v13
    v_and_b32 v52, v48, v14
    v_and_b32 v53, v48, v15
    v_and_b32 v54, v48, v16
    v_and_b32 v55, v48, v17
    v_and_b32 v56, v48, v18
    v_and_b32 v57, v48, v19
    s_waitcnt vmcnt(8)
    v_mfma_f32_16x16x16_bf16 v[20:23], v[50:51], v[64:65], v[20:23]
    v_mfma_f32_16x16x16_bf16 v[24:27], v[50:51], v[66:67], v[24:27]
    v_mfma_f32_16x16x16_bf16 v[20:23], v[52:53], v[68:69], v[20:23]
    v_mfma_f32_16x16x16_bf16 v[24:27], v[52:53], v[70:71], v[24:27]
    v_mfma_f32_16x16x16_bf16 v[20:23], v[54:55], v[72:73], v[20:23]
    v_mfma_f32_16x16x16_bf16 v[24:27], v[54:55], v[74:75], v[24:27]
    v_mfma_f32_16x16x16_bf16 v[20:23], v[56:57], v[76:77], v[20:23]
    v_mfma_f32_16x16x16_bf16 v[24:27], v[56:57], v[78:79], v[24:27]
    s_cmp_le_i32 s78, 20
    s_cbranch_scc1 B_CV_0_F
    s_waitcnt vmcnt(5)
    buffer_load_dwordx4 v[64:67], v1, s[8:11], s45 offen offset:0 nt
    s_waitcnt vmcnt(5)
    buffer_load_dwordx4 v[68:71], v1, s[8:11], s45 offen offset:1024 nt
    s_waitcnt vmcnt(5)
    buffer_load_dwordx4 v[72:75], v1, s[8:11], s45 offen offset:2048 nt
    s_waitcnt vmcnt(5)
    buffer_load_dwordx4 v[76:79], v1, s[8:11], s45 offen offset:3072 nt
    s_branch B_CV_0_E
B_CV_0_F:
    buffer_load_dwordx4 v[64:67], v1, s[8:11], s45 offen offset:0 nt
    buffer_load_dwordx4 v[68:71], v1, s[8:11], s45 offen offset:1024 nt
    buffer_load_dwordx4 v[72:75], v1, s[8:11], s45 offen offset:2048 nt
    buffer_load_dwordx4 v[76:79], v1, s[8:11], s45 offen offset:3072 nt
B_CV_0_E:
    s_sub_u32 s78, s78, 1
    s_add_u32 s45, s45, 0x4000
    s_cmp_eq_u32 s45, s46
    s_cselect_b32 s45, s47, s45
    s_cmp_eq_u32 s45, s48
    s_cselect_b32 s45, s97, s45
    s_cselect_b32 s8, s26, s8
    s_cselect_b32 s9, s27, s9
    s_cselect_b32 s10, s96, s10
    s_cselect_b32 s96, 0, s96
    s_mov_b32 s51, 1
    s_sub_u32 s49, s49, 1
    s_cmp_eq_u32 s49, 0
    s_cbranch_scc1 B_VEVENT
B_V_1:
    s_waitcnt lgkmcnt(0)
    v_fma_f32 v47, v144, s54, -v38
    ds_read_b32 v144, v141
    v_exp_f32 v47, v47
    v_add_u32 v141, 0x100, v141
    v_add_f32 v39, v39, v47
    v_cvt_pk_bf16_f32 v48, v47, v47
    v_and_b32 v50, v48, v12
    v_and_b32 v51, v48, v13
    v_and_b32 v52, v48, v14
    v_and_b32 v53, v48, v15
    v_and_b32 v54, v48, v16
    v_and_b32 v55, v48, v17
    v_and_b32 v56, v48, v18
    v_and_b32 v57, v48, v19
    s_waitcnt vmcnt(8)
    v_mfma_f32_16x16x16_bf16 v[20:23], v[50:51], v[80:81], v[20:23]
    v_mfma_f32_16x16x16_bf16 v[24:27], v[50:51], v[82:83], v[24:27]
    v_mfma_f32_16x16x16_bf16 v[20:23], v[52:53], v[84:85], v[20:23]
    v_mfma_f32_16x16x16_bf16 v[24:27], v[52:53], v[86:87], v[24:27]
    v_mfma_f32_16x16x16_bf16 v[20:23], v[54:55], v[88:89], v[20:23]
    v_mfma_f32_16x16x16_bf16 v[24:27], v[54:55], v[90:91], v[24:27]
    v_mfma_f32_16x16x16_bf16 v[20:23], v[56:57], v[92:93], v[20:23]
    v_mfma_f32_16x16x16_bf16 v[24:27], v[56:57], v[94:95], v[24:27]
    s_cmp_le_i32 s78, 20
    s_cbranch_scc1 B_CV_1_F
    s_waitcnt vmcnt(5)
    buffer_load_dwordx4 v[80:83], v1, s[8:11], s45 offen offset:0 nt
    s_waitcnt vmcnt(5)
    buffer_load_dwordx4 v[84:87], v1, s[8:11], s45 offen offset:1024 nt
    s_waitcnt vmcnt(5)
    buffer_load_dwordx4 v[88:91], v1, s[8:11], s45 offen offset:2048 nt
    s_waitcnt vmcnt(5)
    buffer_load_dwordx4 v[92:95], v1, s[8:11], s45 offen offset:3072 nt
    s_branch B_CV_1_E
B_CV_1_F:
    buffer_load_dwordx4 v[80:83], v1, s[8:11], s45 offen offset:0 nt
    buffer_load_dwordx4 v[84:87], v1, s[8:11], s45 offen offset:1024 nt
    buffer_load_dwordx4 v[88:91], v1, s[8:11], s45 offen offset:2048 nt
    buffer_load_dwordx4 v[92:95], v1, s[8:11], s45 offen offset:3072 nt
B_CV_1_E:
    s_sub_u32 s78, s78, 1
    s_add_u32 s45, s45, 0x4000
    s_cmp_eq_u32 s45, s46
    s_cselect_b32 s45, s47, s45
    s_cmp_eq_u32 s45, s48
    s_cselect_b32 s45, s97, s45
    s_cselect_b32 s8, s26, s8
    s_cselect_b32 s9, s27, s9
    s_cselect_b32 s10, s96, s10
    s_cselect_b32 s96, 0, s96
    s_mov_b32 s51, 2
    s_sub_u32 s49, s49, 1
    s_cmp_eq_u32 s49, 0
    s_cbranch_scc1 B_VEVENT
B_V_2:
    s_waitcnt lgkmcnt(0)
    v_fma_f32 v47, v144, s54, -v38
    ds_read_b32 v144, v141
    v_exp_f32 v47, v47
    v_add_u32 v141, 0x100, v141
    v_add_f32 v39, v39, v47
    v_cvt_pk_bf16_f32 v48, v47, v47
    v_and_b32 v50, v48, v12
    v_and_b32 v51, v48, v13
    v_and_b32 v52, v48, v14
    v_and_b32 v53, v48, v15
    v_and_b32 v54, v48, v16
    v_and_b32 v55, v48, v17
    v_and_b32 v56, v48, v18
    v_and_b32 v57, v48, v19
    s_waitcnt vmcnt(8)
    v_mfma_f32_16x16x16_bf16 v[20:23], v[50:51], v[96:97], v[20:23]
    v_mfma_f32_16x16x16_bf16 v[24:27], v[50:51], v[98:99], v[24:27]
    v_mfma_f32_16x16x16_bf16 v[20:23], v[52:53], v[100:101], v[20:23]
    v_mfma_f32_16x16x16_bf16 v[24:27], v[52:53], v[102:103], v[24:27]
    v_mfma_f32_16x16x16_bf16 v[20:23], v[54:55], v[104:105], v[20:23]
    v_mfma_f32_16x16x16_bf16 v[24:27], v[54:55], v[106:107], v[24:27]
    v_mfma_f32_16x16x16_bf16 v[20:23], v[56:57], v[108:109], v[20:23]
    v_mfma_f32_16x16x16_bf16 v[24:27], v[56:57], v[110:111], v[24:27]
    s_cmp_le_i32 s78, 20
    s_cbranch_scc1 B_CV_2_F
    s_waitcnt vmcnt(5)
    buffer_load_dwordx4 v[96:99], v1, s[8:11], s45 offen offset:0 nt
    s_waitcnt vmcnt(5)
    buffer_load_dwordx4 v[100:103], v1, s[8:11], s45 offen offset:1024 nt
    s_waitcnt vmcnt(5)
    buffer_load_dwordx4 v[104:107], v1, s[8:11], s45 offen offset:2048 nt
    s_waitcnt vmcnt(5)
    buffer_load_dwordx4 v[108:111], v1, s[8:11], s45 offen offset:3072 nt
    s_branch B_CV_2_E
B_CV_2_F:
    buffer_load_dwordx4 v[96:99], v1, s[8:11], s45 offen offset:0 nt
    buffer_load_dwordx4 v[100:103], v1, s[8:11], s45 offen offset:1024 nt
    buffer_load_dwordx4 v[104:107], v1, s[8:11], s45 offen offset:2048 nt
    buffer_load_dwordx4 v[108:111], v1, s[8:11], s45 offen offset:3072 nt
B_CV_2_E:
    s_sub_u32 s78, s78, 1
    s_add_u32 s45, s45, 0x4000
    s_cmp_eq_u32 s45, s46
    s_cselect_b32 s45, s47, s45
    s_cmp_eq_u32 s45, s48
    s_cselect_b32 s45, s97, s45
    s_cselect_b32 s8, s26, s8
    s_cselect_b32 s9, s27, s9
    s_cselect_b32 s10, s96, s10
    s_cselect_b32 s96, 0, s96
    s_mov_b32 s51, 0
    s_sub_u32 s49, s49, 1
    s_cmp_eq_u32 s49, 0
    s_cbranch_scc1 B_VEVENT
    s_branch B_V_0
B_VEVENT:
    s_cmp_eq_u32 s50, 0
    s_cbranch_scc1 B_FIN
    v_mov_b32 v28, v20
    v_mov_b32 v20, 0
    v_mov_b32 v29, v21
    v_mov_b32 v21, 0
    v_mov_b32 v30, v22
    v_mov_b32 v22, 0
    v_mov_b32 v31, v23
    v_mov_b32 v23, 0
    v_mov_b32 v32, v24
    v_mov_b32 v24, 0
    v_mov_b32 v33, v25
    v_mov_b32 v25, 0
    v_mov_b32 v34, v26
    v_mov_b32 v26, 0
    v_mov_b32 v35, v27
    v_mov_b32 v27, 0
    v_mov_b32 v37, v39
    v_mov_b32 v39, 0
    v_mov_b32 v38, v143
    s_mov_b32 s50, 0
    s_mov_b32 s49, s99
    s_cmp_eq_u32 s51, 1
    s_cbranch_scc1 B_V_1
    s_cmp_eq_u32 s51, 2
    s_cbranch_scc1 B_V_2
    s_branch B_V_0
B_FIN:
    ds_write_b128 v128, v[28:31] offset:4096
    v_add_f32_dpp v37, v37, v37 row_ror:4 row_mask:0xf bank_mask:0xf
    v_add_f32_dpp v39, v39, v39 row_ror:4 row_mask:0xf bank_mask:0xf
    ds_write_b128 v128, v[32:35] offset:4112
    ds_write_b128 v128, v[20:23] offset:12288
    v_add_f32_dpp v37, v37, v37 row_ror:8 row_mask:0xf bank_mask:0xf
    v_add_f32_dpp v39, v39, v39 row_ror:8 row_mask:0xf bank_mask:0xf
    ds_write_b128 v128, v[24:27] offset:12304
    ds_write_b32 v129, v37 offset:20544
    ds_write_b32 v129, v39 offset:20608
    v_mov_b32 v28, 0
    v_mov_b32 v29, 0
    v_mov_b32 v30, 0
    v_mov_b32 v31, 0
    s_waitcnt lgkmcnt(0)
    s_barrier
    ds_read2st64_b32 v[208:209], v131 offset0:16 offset1:18
    ds_read2st64_b32 v[210:211], v131 offset0:20 offset1:22
    ds_read2st64_b32 v[212:213], v131 offset0:24 offset1:26
    ds_read2st64_b32 v[214:215], v131 offset0:28 offset1:30
    ds_read2st64_b32 v[216:217], v131 offset0:32 offset1:34
    ds_read2st64_b32 v[218:219], v131 offset0:36 offset1:38
    ds_read2st64_b32 v[220:221], v131 offset0:40 offset1:42
    ds_read2st64_b32 v[222:223], v131 offset0:44 offset1:46
    s_waitcnt lgkmcnt(6)
    v_add_f32 v208, v208, v209
    v_add_f32 v210, v210, v211
    v_add_f32 v208, v208, v210
    s_waitcnt lgkmcnt(4)
    v_add_f32 v212, v212, v213
    v_add_f32 v214, v214, v215
    v_add_f32 v212, v212, v214
    v_add_f32 v208, v208, v212
    s_waitcnt lgkmcnt(2)
    v_add_f32 v216, v216, v217
    v_add_f32 v218, v218, v219
    v_add_f32 v216, v216, v218
    s_waitcnt lgkmcnt(0)
    v_add_f32 v220, v220, v221
    v_add_f32 v222, v222, v223
    v_add_f32 v220, v220, v222
    v_add_f32 v216, v216, v220
    v_add_f32 v208, v208, v216
    v_cvt_pk_bf16_f32 v198, v208, v208
    ds_write_b16 v133, v198 offset:20992
    s_waitcnt lgkmcnt(0)
    s_barrier
    ds_read_b128 v[208:211], v134 offset:20992
    ds_read_b128 v[212:215], v135 offset:20992
    ds_read_b128 v[216:219], v136 offset:20992
    ds_read_b128 v[220:223], v137 offset:20992
    ds_read_b128 v[4:7], v139 offset:20544
    ds_read_b128 v[8:11], v139 offset:20560
    ds_read_b128 v[12:15], v139 offset:20576
    ds_read_b128 v[16:19], v139 offset:20592
    s_waitcnt lgkmcnt(7)
    v_perm_b32 v224, v208, v208, v240
    v_perm_b32 v225, v208, v208, v241
    v_perm_b32 v226, v208, v208, v242
    v_perm_b32 v227, v208, v208, v243
    v_perm_b32 v228, v208, v208, v244
    v_perm_b32 v229, v208, v208, v245
    v_perm_b32 v230, v208, v208, v246
    v_perm_b32 v231, v208, v208, v247
    v_mfma_f32_16x16x32_bf16 v[28:31], v[224:227], a[0:3], v[28:31]
    v_perm_b32 v232, v209, v209, v240
    v_perm_b32 v233, v209, v209, v241
    v_perm_b32 v234, v209, v209, v242
    v_perm_b32 v235, v209, v209, v243
    v_mfma_f32_16x16x32_bf16 v[28:31], v[228:231], a[4:7], v[28:31]
    v_perm_b32 v236, v209, v209, v244
    v_perm_b32 v237, v209, v209, v245
    v_perm_b32 v238, v209, v209, v246
    v_perm_b32 v239, v209, v209, v247
    v_mfma_f32_16x16x32_bf16 v[28:31], v[232:235], a[8:11], v[28:31]
    v_perm_b32 v224, v210, v210, v240
    v_perm_b32 v225, v210, v210, v241
    v_perm_b32 v226, v210, v210, v242
    v_perm_b32 v227, v210, v210, v243
    v_mfma_f32_16x16x32_bf16 v[28:31], v[236:239], a[12:15], v[28:31]
    v_perm_b32 v228, v210, v210, v244
    v_perm_b32 v229, v210, v210, v245
    v_perm_b32 v230, v210, v210, v246
    v_perm_b32 v231, v210, v210, v247
    v_mfma_f32_16x16x32_bf16 v[28:31], v[224:227], a[16:19], v[28:31]
    v_perm_b32 v232, v211, v211, v240
    v_perm_b32 v233, v211, v211, v241
    v_perm_b32 v234, v211, v211, v242
    v_perm_b32 v235, v211, v211, v243
    v_mfma_f32_16x16x32_bf16 v[28:31], v[228:231], a[20:23], v[28:31]
    v_perm_b32 v236, v211, v211, v244
    v_perm_b32 v237, v211, v211, v245
    v_perm_b32 v238, v211, v211, v246
    v_perm_b32 v239, v211, v211, v247
    v_mfma_f32_16x16x32_bf16 v[28:31], v[232:235], a[24:27], v[28:31]
    s_waitcnt lgkmcnt(6)
    v_perm_b32 v224, v212, v212, v240
    v_perm_b32 v225, v212, v212, v241
    v_perm_b32 v226, v212, v212, v242
    v_perm_b32 v227, v212, v212, v243
    v_mfma_f32_16x16x32_bf16 v[28:31], v[236:239], a[28:31], v[28:31]
    v_perm_b32 v228, v212, v212, v244
    v_perm_b32 v229, v212, v212, v245
    v_perm_b32 v230, v212, v212, v246
    v_perm_b32 v231, v212, v212, v247
    v_mfma_f32_16x16x32_bf16 v[28:31], v[224:227], a[32:35], v[28:31]
    v_perm_b32 v232, v213, v213, v240
    v_perm_b32 v233, v213, v213, v241
    v_perm_b32 v234, v213, v213, v242
    v_perm_b32 v235, v213, v213, v243
    v_mfma_f32_16x16x32_bf16 v[28:31], v[228:231], a[36:39], v[28:31]
    v_perm_b32 v236, v213, v213, v244
    v_perm_b32 v237, v213, v213, v245
    v_perm_b32 v238, v213, v213, v246
    v_perm_b32 v239, v213, v213, v247
    v_mfma_f32_16x16x32_bf16 v[28:31], v[232:235], a[40:43], v[28:31]
    v_perm_b32 v224, v214, v214, v240
    v_perm_b32 v225, v214, v214, v241
    v_perm_b32 v226, v214, v214, v242
    v_perm_b32 v227, v214, v214, v243
    v_mfma_f32_16x16x32_bf16 v[28:31], v[236:239], a[44:47], v[28:31]
    v_perm_b32 v228, v214, v214, v244
    v_perm_b32 v229, v214, v214, v245
    v_perm_b32 v230, v214, v214, v246
    v_perm_b32 v231, v214, v214, v247
    v_mfma_f32_16x16x32_bf16 v[28:31], v[224:227], a[48:51], v[28:31]
    v_perm_b32 v232, v215, v215, v240
    v_perm_b32 v233, v215, v215, v241
    v_perm_b32 v234, v215, v215, v242
    v_perm_b32 v235, v215, v215, v243
    v_mfma_f32_16x16x32_bf16 v[28:31], v[228:231], a[52:55], v[28:31]
    v_perm_b32 v236, v215, v215, v244
    v_perm_b32 v237, v215, v215, v245
    v_perm_b32 v238, v215, v215, v246
    v_perm_b32 v239, v215, v215, v247
    v_mfma_f32_16x16x32_bf16 v[28:31], v[232:235], a[56:59], v[28:31]
    s_waitcnt lgkmcnt(5)
    v_perm_b32 v224, v216, v216, v240
    v_perm_b32 v225, v216, v216, v241
    v_perm_b32 v226, v216, v216, v242
    v_perm_b32 v227, v216, v216, v243
    v_mfma_f32_16x16x32_bf16 v[28:31], v[236:239], a[60:63], v[28:31]
    v_perm_b32 v228, v216, v216, v244
    v_perm_b32 v229, v216, v216, v245
    v_perm_b32 v230, v216, v216, v246
    v_perm_b32 v231, v216, v216, v247
    v_mfma_f32_16x16x32_bf16 v[28:31], v[224:227], a[64:67], v[28:31]
    v_perm_b32 v232, v217, v217, v240
    v_perm_b32 v233, v217, v217, v241
    v_perm_b32 v234, v217, v217, v242
    v_perm_b32 v235, v217, v217, v243
    v_mfma_f32_16x16x32_bf16 v[28:31], v[228:231], a[68:71], v[28:31]
    v_perm_b32 v236, v217, v217, v244
    v_perm_b32 v237, v217, v217, v245
    v_perm_b32 v238, v217, v217, v246
    v_perm_b32 v239, v217, v217, v247
    v_mfma_f32_16x16x32_bf16 v[28:31], v[232:235], a[72:75], v[28:31]
    v_perm_b32 v224, v218, v218, v240
    v_perm_b32 v225, v218, v218, v241
    v_perm_b32 v226, v218, v218, v242
    v_perm_b32 v227, v218, v218, v243
    v_mfma_f32_16x16x32_bf16 v[28:31], v[236:239], a[76:79], v[28:31]
    v_perm_b32 v228, v218, v218, v244
    v_perm_b32 v229, v218, v218, v245
    v_perm_b32 v230, v218, v218, v246
    v_perm_b32 v231, v218, v218, v247
    v_mfma_f32_16x16x32_bf16 v[28:31], v[224:227], a[80:83], v[28:31]
    v_perm_b32 v232, v219, v219, v240
    v_perm_b32 v233, v219, v219, v241
    v_perm_b32 v234, v219, v219, v242
    v_perm_b32 v235, v219, v219, v243
    v_mfma_f32_16x16x32_bf16 v[28:31], v[228:231], a[84:87], v[28:31]
    v_perm_b32 v236, v219, v219, v244
    v_perm_b32 v237, v219, v219, v245
    v_perm_b32 v238, v219, v219, v246
    v_perm_b32 v239, v219, v219, v247
    v_mfma_f32_16x16x32_bf16 v[28:31], v[232:235], a[88:91], v[28:31]
    s_waitcnt lgkmcnt(4)
    v_perm_b32 v224, v220, v220, v240
    v_perm_b32 v225, v220, v220, v241
    v_perm_b32 v226, v220, v220, v242
    v_perm_b32 v227, v220, v220, v243
    v_mfma_f32_16x16x32_bf16 v[28:31], v[236:239], a[92:95], v[28:31]
    v_perm_b32 v228, v220, v220, v244
    v_perm_b32 v229, v220, v220, v245
    v_perm_b32 v230, v220, v220, v246
    v_perm_b32 v231, v220, v220, v247
    v_mfma_f32_16x16x32_bf16 v[28:31], v[224:227], a[96:99], v[28:31]
    v_perm_b32 v232, v221, v221, v240
    v_perm_b32 v233, v221, v221, v241
    v_perm_b32 v234, v221, v221, v242
    v_perm_b32 v235, v221, v221, v243
    v_mfma_f32_16x16x32_bf16 v[28:31], v[228:231], a[100:103], v[28:31]
    v_perm_b32 v236, v221, v221, v244
    v_perm_b32 v237, v221, v221, v245
    v_perm_b32 v238, v221, v221, v246
    v_perm_b32 v239, v221, v221, v247
    v_mfma_f32_16x16x32_bf16 v[28:31], v[232:235], a[104:107], v[28:31]
    v_perm_b32 v224, v222, v222, v240
    v_perm_b32 v225, v222, v222, v241
    v_perm_b32 v226, v222, v222, v242
    v_perm_b32 v227, v222, v222, v243
    v_mfma_f32_16x16x32_bf16 v[28:31], v[236:239], a[108:111], v[28:31]
    v_perm_b32 v228, v222, v222, v244
    v_perm_b32 v229, v222, v222, v245
    v_perm_b32 v230, v222, v222, v246
    v_perm_b32 v231, v222, v222, v247
    v_mfma_f32_16x16x32_bf16 v[28:31], v[224:227], a[112:115], v[28:31]
    v_perm_b32 v232, v223, v223, v240
    v_perm_b32 v233, v223, v223, v241
    v_perm_b32 v234, v223, v223, v242
    v_perm_b32 v235, v223, v223, v243
    v_mfma_f32_16x16x32_bf16 v[28:31], v[228:231], a[116:119], v[28:31]
    v_perm_b32 v236, v223, v223, v244
    v_perm_b32 v237, v223, v223, v245
    v_perm_b32 v238, v223, v223, v246
    v_perm_b32 v239, v223, v223, v247
    v_mfma_f32_16x16x32_bf16 v[28:31], v[232:235], a[120:123], v[28:31]
    s_nop 1
    v_mfma_f32_16x16x32_bf16 v[28:31], v[236:239], a[124:127], v[28:31]
    s_waitcnt lgkmcnt(0)
    v_add_f32 v4, v4, v5
    v_add_f32 v6, v6, v7
    v_add_f32 v8, v8, v9
    v_add_f32 v10, v10, v11
    v_add_f32 v12, v12, v13
    v_add_f32 v14, v14, v15
    v_add_f32 v16, v16, v17
    buffer_store_dwordx4 v[28:31], v248, s[20:23], 0 offen sc1
    v_add_f32 v18, v18, v19
    v_add_f32 v4, v4, v6
    v_add_f32 v8, v8, v10
    v_add_f32 v12, v12, v14
    v_add_f32 v16, v16, v18
    v_add_f32 v4, v4, v8
    v_add_f32 v12, v12, v16
    v_add_f32 v197, v4, v12
    s_cmp_ge_u32 s76, 32
    s_cbranch_scc1 B_READY_ok
    s_mov_b32 s59, 0
    v_mov_b32 v47, 0
B_READY:
    buffer_load_dword v48, v47, s[36:39], 0 offen sc1
    s_add_u32 s59, s59, 1
    s_waitcnt vmcnt(0)
    v_readfirstlane_b32 s52, v48
    s_cmp_ge_u32 s52, 32
    s_cbranch_scc1 B_READY_ok
    s_sleep 64
    s_cmp_lt_u32 s59, 0x40000
    s_cbranch_scc1 B_READY
B_READY_ok:
    s_mov_b64 exec, 15
    s_waitcnt vmcnt(0)
    buffer_store_dwordx2 v[196:197], v249, s[20:23], 0 offen sc1
    s_endpgm
L_EXIT:
    s_endpgm
A_PATH:
    s_load_dwordx8 s[24:31], s[0:1], 0
    s_load_dwordx2 s[4:5], s[0:1], 32
    s_load_dwordx2 s[6:7], s[0:1], 80
    s_load_dwordx4 s[32:35], s[0:1], 88
    v_lshrrev_b32 v1, 6, v0
    v_and_b32 v2, 63, v0
    v_readfirstlane_b32 s3, v1
    v_lshrrev_b32 v3, 4, v2
    v_and_b32 v58, 15, v0
    s_mov_b32 s42, s41
    s_lshl_b32 s52, s42, 3
    s_add_u32 s52, s52, s40
    s_lshl_b32 s45, s52, 21
    s_add_u32 s45, s45, 0x180000
    s_add_u32 s48, s45, 0x80000
    s_lshl_b32 s52, s3, 12
    v_lshl_add_u32 v1, v2, 4, s52
    s_lshl_b32 s52, s42, 10
    v_lshl_add_u32 v60, v3, 6, s52
    s_lshl_b32 s52, s40, 2
    s_add_u32 s52, s52, s3
    s_lshl_b32 s52, s52, 8
    v_lshl_add_u32 v61, v3, 18, s52
    v_lshl_add_u32 v61, v58, 4, v61
    s_lshl_b32 s52, s40, 19
    s_lshl_b32 s53, s3, 8
    s_add_u32 s52, s52, s53
    v_lshl_add_u32 v62, v3, 15, s52
    v_lshl_add_u32 v62, v58, 4, v62
    s_waitcnt lgkmcnt(0)
    s_mov_b32 s20, s34
    s_mov_b32 s21, s35
    s_mov_b32 s22, 0x200000
    s_mov_b32 s23, 0x20000
    s_lshl_b32 s52, s42, 3
    s_add_u32 s52, s52, s40
    s_lshl_b32 s52, s52, 2
    s_add_u32 s52, s52, s3
    s_lshl_b32 s52, s52, 8
    s_add_u32 s52, s52, 0x100000
    v_lshl_add_u32 v47, v2, 2, s52
    v_mov_b32 v48, -1
    buffer_store_dword v48, v47, s[20:23], 0 offen sc1
    s_add_u32 s53, s42, 1
    s_and_b32 s53, s53, 2
    s_lshr_b32 s53, s53, 1
    s_add_u32 s57, s53, 2
    s_lshl_b32 s52, s42, 7
    s_lshl_b32 s53, s3, 5
    s_add_u32 s52, s52, s53
    s_lshl_b32 s52, s52, 11
    s_lshl_b32 s53, s40, 8
    s_add_u32 s52, s52, s53
    v_lshl_add_u32 v250, v3, 11, s52
    v_lshl_add_u32 v250, v58, 4, v250
    v_cmp_gt_u32 vcc, s57, v3
    v_mov_b32 v47, 0x400000
    s_nop 0
    v_cndmask_b32 v250, v47, v250, vcc
    s_mov_b32 s20, s24
    s_mov_b32 s21, s25
    s_mov_b32 s22, 0x1000
    s_mov_b32 s23, 0x20000
    s_mov_b32 s16, s30
    s_mov_b32 s17, s31
    s_mov_b32 s18, 0x400000
    s_mov_b32 s19, 0x20000
    buffer_load_dwordx4 v[160:163], v60, s[20:23], 0 offen offset:0
    buffer_load_dwordx4 v[164:167], v60, s[20:23], 0 offen offset:16
    buffer_load_dwordx4 v[168:171], v60, s[20:23], 0 offen offset:32
    buffer_load_dwordx4 v[172:175], v60, s[20:23], 0 offen offset:48
    buffer_load_dwordx4 v[176:179], v60, s[20:23], 0 offen offset:256
    buffer_load_dwordx4 v[180:183], v60, s[20:23], 0 offen offset:272
    buffer_load_dwordx4 v[184:187], v60, s[20:23], 0 offen offset:288
    buffer_load_dwordx4 v[188:191], v60, s[20:23], 0 offen offset:304
    buffer_load_dwordx4 v[192:195], v60, s[20:23], 0 offen offset:512
    buffer_load_dwordx4 v[196:199], v60, s[20:23], 0 offen offset:528
    buffer_load_dwordx4 v[200:203], v60, s[20:23], 0 offen offset:544
    buffer_load_dwordx4 v[204:207], v60, s[20:23], 0 offen offset:560
    buffer_load_dwordx4 v[208:211], v60, s[20:23], 0 offen offset:768
    buffer_load_dwordx4 v[212:215], v60, s[20:23], 0 offen offset:784
    buffer_load_dwordx4 v[216:219], v60, s[20:23], 0 offen offset:800
    buffer_load_dwordx4 v[220:223], v60, s[20:23], 0 offen offset:816
    s_mov_b32 s58, 0x0
    buffer_load_dwordx4 a[0:3], v61, s[16:19], s58 offen
    s_mov_b32 s58, 0x2000
    buffer_load_dwordx4 a[4:7], v61, s[16:19], s58 offen
    s_mov_b32 s58, 0x4000
    buffer_load_dwordx4 a[8:11], v61, s[16:19], s58 offen
    s_mov_b32 s58, 0x6000
    buffer_load_dwordx4 a[12:15], v61, s[16:19], s58 offen
    s_mov_b32 s58, 0x8000
    buffer_load_dwordx4 a[16:19], v61, s[16:19], s58 offen
    s_mov_b32 s58, 0xa000
    buffer_load_dwordx4 a[20:23], v61, s[16:19], s58 offen
    s_mov_b32 s58, 0xc000
    buffer_load_dwordx4 a[24:27], v61, s[16:19], s58 offen
    s_mov_b32 s58, 0xe000
    buffer_load_dwordx4 a[28:31], v61, s[16:19], s58 offen
    s_mov_b32 s58, 0x10000
    buffer_load_dwordx4 a[32:35], v61, s[16:19], s58 offen
    s_mov_b32 s58, 0x12000
    buffer_load_dwordx4 a[36:39], v61, s[16:19], s58 offen
    s_mov_b32 s58, 0x14000
    buffer_load_dwordx4 a[40:43], v61, s[16:19], s58 offen
    s_mov_b32 s58, 0x16000
    buffer_load_dwordx4 a[44:47], v61, s[16:19], s58 offen
    s_mov_b32 s58, 0x18000
    buffer_load_dwordx4 a[48:51], v61, s[16:19], s58 offen
    s_mov_b32 s58, 0x1a000
    buffer_load_dwordx4 a[52:55], v61, s[16:19], s58 offen
    s_mov_b32 s58, 0x1c000
    buffer_load_dwordx4 a[56:59], v61, s[16:19], s58 offen
    s_mov_b32 s58, 0x1e000
    buffer_load_dwordx4 a[60:63], v61, s[16:19], s58 offen
    s_mov_b32 s58, 0x20000
    buffer_load_dwordx4 a[64:67], v61, s[16:19], s58 offen
    s_mov_b32 s58, 0x22000
    buffer_load_dwordx4 a[68:71], v61, s[16:19], s58 offen
    s_mov_b32 s58, 0x24000
    buffer_load_dwordx4 a[72:75], v61, s[16:19], s58 offen
    s_mov_b32 s58, 0x26000
    buffer_load_dwordx4 a[76:79], v61, s[16:19], s58 offen
    s_mov_b32 s58, 0x28000
    buffer_load_dwordx4 a[80:83], v61, s[16:19], s58 offen
    s_mov_b32 s58, 0x2a000
    buffer_load_dwordx4 a[84:87], v61, s[16:19], s58 offen
    s_mov_b32 s58, 0x2c000
    buffer_load_dwordx4 a[88:91], v61, s[16:19], s58 offen
    s_mov_b32 s58, 0x2e000
    buffer_load_dwordx4 a[92:95], v61, s[16:19], s58 offen
    s_mov_b32 s58, 0x30000
    buffer_load_dwordx4 a[96:99], v61, s[16:19], s58 offen
    s_mov_b32 s58, 0x32000
    buffer_load_dwordx4 a[100:103], v61, s[16:19], s58 offen
    s_mov_b32 s58, 0x34000
    buffer_load_dwordx4 a[104:107], v61, s[16:19], s58 offen
    s_mov_b32 s58, 0x36000
    buffer_load_dwordx4 a[108:111], v61, s[16:19], s58 offen
    s_mov_b32 s58, 0x38000
    buffer_load_dwordx4 a[112:115], v61, s[16:19], s58 offen
    s_mov_b32 s58, 0x3a000
    buffer_load_dwordx4 a[116:119], v61, s[16:19], s58 offen
    s_mov_b32 s58, 0x3c000
    buffer_load_dwordx4 a[120:123], v61, s[16:19], s58 offen
    s_mov_b32 s58, 0x3e000
    buffer_load_dwordx4 a[124:127], v61, s[16:19], s58 offen
    s_mov_b32 s8, s26
    s_mov_b32 s9, s27
    s_mov_b32 s10, 0x4000000
    s_mov_b32 s11, 0x20000
    s_mov_b32 s12, s28
    s_mov_b32 s13, s29
    s_mov_b32 s14, 0x4000000
    s_mov_b32 s15, 0x20000
    s_mov_b32 s36, s32
    s_mov_b32 s37, s33
    s_mov_b32 s38, 0x100
    s_mov_b32 s39, 0x20000
    v_and_b32 v47, 1, v0
    v_bfe_u32 v48, v0, 1, 2
    v_cmp_eq_u32 vcc, 1, v47
    v_mov_b32 v49, 0x0c0c0100
    v_mov_b32 v59, 0x01000c0c
    v_cndmask_b32 v49, v49, v59, vcc
    v_mov_b32 v47, 0x0c0c0302
    v_mov_b32 v59, 0x03020c0c
    v_cndmask_b32 v47, v47, v59, vcc
    v_mov_b32 v59, 0x0c0c0c0c
    v_cmp_eq_u32 vcc, 0, v48
    s_nop 1
    v_cndmask_b32 v240, v59, v49, vcc
    v_cndmask_b32 v244, v59, v47, vcc
    v_cmp_eq_u32 vcc, 1, v48
    s_nop 1
    v_cndmask_b32 v241, v59, v49, vcc
    v_cndmask_b32 v245, v59, v47, vcc
    v_cmp_eq_u32 vcc, 2, v48
    s_nop 1
    v_cndmask_b32 v242, v59, v49, vcc
    v_cndmask_b32 v246, v59, v47, vcc
    v_cmp_eq_u32 vcc, 3, v48
    s_nop 1
    v_cndmask_b32 v243, v59, v49, vcc
    v_cndmask_b32 v247, v59, v47, vcc
    v_and_b32 v47, 1, v0
    v_cmp_eq_u32 vcc, 1, v47
    v_mov_b32 v48, 0xffff
    v_mov_b32 v49, 0xffff0000
    v_cndmask_b32 v48, v48, v49, vcc
    v_bfe_u32 v47, v0, 1, 1
    v_cmp_eq_u32 vcc, 0, v47
    s_mov_b32 s54, 0x3fb8aa3b
    s_mov_b32 s55, 0x3db504f3
    v_cndmask_b32 v36, 0, v48, vcc
    v_cndmask_b32 v37, v48, 0, vcc
    s_mov_b32 s56, 0xffff0000
    v_mov_b32 v20, 0
    v_mov_b32 v21, 0
    v_mov_b32 v22, 0
    v_mov_b32 v23, 0
    v_mov_b32 v24, 0
    v_mov_b32 v25, 0
    v_mov_b32 v26, 0
    v_mov_b32 v27, 0
    v_mov_b32 v28, 0
    v_mov_b32 v29, 0
    v_mov_b32 v30, 0
    v_mov_b32 v31, 0
    v_mov_b32 v38, 0xff800000
    v_mov_b32 v39, 0
    s_waitcnt vmcnt(48)
    s_barrier
    s_cmp_eq_u32 s3, 0
    s_cbranch_scc0 A_NOSIG
    v_mov_b32 v47, 0
    v_mov_b32 v48, 1
    s_mov_b64 exec, 1
    buffer_atomic_add v48, v47, s[36:39], 0 offen
    s_mov_b64 exec, -1
A_NOSIG:
    s_waitcnt vmcnt(31)
    s_mov_b32 s58, 0x100000
    buffer_load_dwordx4 a[128:131], v61, s[16:19], s58 offen
    s_mov_b32 s58, 0x102000
    buffer_load_dwordx4 a[132:135], v61, s[16:19], s58 offen
    s_mov_b32 s58, 0x104000
    buffer_load_dwordx4 a[136:139], v61, s[16:19], s58 offen
    s_mov_b32 s58, 0x106000
    buffer_load_dwordx4 a[140:143], v61, s[16:19], s58 offen
    s_mov_b32 s58, 0x108000
    buffer_load_dwordx4 a[144:147], v61, s[16:19], s58 offen
    s_mov_b32 s58, 0x10a000
    buffer_load_dwordx4 a[148:151], v61, s[16:19], s58 offen
    s_mov_b32 s58, 0x10c000
    buffer_load_dwordx4 a[152:155], v61, s[16:19], s58 offen
    s_mov_b32 s58, 0x10e000
    buffer_load_dwordx4 a[156:159], v61, s[16:19], s58 offen
    s_mov_b32 s58, 0x110000
    buffer_load_dwordx4 a[160:163], v61, s[16:19], s58 offen
    s_mov_b32 s58, 0x112000
    buffer_load_dwordx4 a[164:167], v61, s[16:19], s58 offen
    s_mov_b32 s58, 0x114000
    buffer_load_dwordx4 a[168:171], v61, s[16:19], s58 offen
    s_mov_b32 s58, 0x116000
    buffer_load_dwordx4 a[172:175], v61, s[16:19], s58 offen
    s_mov_b32 s58, 0x118000
    buffer_load_dwordx4 a[176:179], v61, s[16:19], s58 offen
    s_mov_b32 s58, 0x11a000
    buffer_load_dwordx4 a[180:183], v61, s[16:19], s58 offen
    s_mov_b32 s58, 0x11c000
    buffer_load_dwordx4 a[184:187], v61, s[16:19], s58 offen
    s_mov_b32 s58, 0x11e000
    buffer_load_dwordx4 a[188:191], v61, s[16:19], s58 offen
    s_mov_b32 s58, 0x120000
    buffer_load_dwordx4 a[192:195], v61, s[16:19], s58 offen
    s_mov_b32 s58, 0x122000
    buffer_load_dwordx4 a[196:199], v61, s[16:19], s58 offen
    s_mov_b32 s58, 0x124000
    buffer_load_dwordx4 a[200:203], v61, s[16:19], s58 offen
    s_mov_b32 s58, 0x126000
    buffer_load_dwordx4 a[204:207], v61, s[16:19], s58 offen
    s_mov_b32 s58, 0x128000
    buffer_load_dwordx4 a[208:211], v61, s[16:19], s58 offen
    s_mov_b32 s58, 0x12a000
    buffer_load_dwordx4 a[212:215], v61, s[16:19], s58 offen
    s_mov_b32 s58, 0x12c000
    buffer_load_dwordx4 a[216:219], v61, s[16:19], s58 offen
    s_mov_b32 s58, 0x12e000
    buffer_load_dwordx4 a[220:223], v61, s[16:19], s58 offen
    s_mov_b32 s58, 0x130000
    buffer_load_dwordx4 a[224:227], v61, s[16:19], s58 offen
    s_mov_b32 s58, 0x132000
    buffer_load_dwordx4 a[228:231], v61, s[16:19], s58 offen
    s_mov_b32 s58, 0x134000
    buffer_load_dwordx4 a[232:235], v61, s[16:19], s58 offen
    s_mov_b32 s58, 0x136000
    buffer_load_dwordx4 a[236:239], v61, s[16:19], s58 offen
    s_mov_b32 s58, 0x138000
    buffer_load_dwordx4 a[240:243], v61, s[16:19], s58 offen
    s_mov_b32 s58, 0x13a000
    buffer_load_dwordx4 a[244:247], v61, s[16:19], s58 offen
    s_mov_b32 s58, 0x13c000
    buffer_load_dwordx4 a[248:251], v61, s[16:19], s58 offen
    s_mov_b32 s58, 0x13e000
    buffer_load_dwordx4 a[252:255], v61, s[16:19], s58 offen
    s_waitcnt vmcnt(32)
    v_perm_b32 v224, v160, v160, v240
    v_perm_b32 v225, v160, v160, v241
    v_perm_b32 v226, v160, v160, v242
    v_perm_b32 v227, v160, v160, v243
    v_perm_b32 v228, v160, v160, v244
    v_perm_b32 v229, v160, v160, v245
    v_perm_b32 v230, v160, v160, v246
    v_perm_b32 v231, v160, v160, v247
    v_mfma_f32_16x16x32_bf16 v[28:31], v[224:227], a[0:3], v[28:31]
    v_perm_b32 v232, v161, v161, v240
    v_perm_b32 v233, v161, v161, v241
    v_perm_b32 v234, v161, v161, v242
    v_perm_b32 v235, v161, v161, v243
    v_mfma_f32_16x16x32_bf16 v[28:31], v[228:231], a[4:7], v[28:31]
    v_perm_b32 v236, v161, v161, v244
    v_perm_b32 v237, v161, v161, v245
    v_perm_b32 v238, v161, v161, v246
    v_perm_b32 v239, v161, v161, v247
    v_mfma_f32_16x16x32_bf16 v[28:31], v[232:235], a[8:11], v[28:31]
    v_perm_b32 v224, v162, v162, v240
    v_perm_b32 v225, v162, v162, v241
    v_perm_b32 v226, v162, v162, v242
    v_perm_b32 v227, v162, v162, v243
    v_mfma_f32_16x16x32_bf16 v[28:31], v[236:239], a[12:15], v[28:31]
    v_perm_b32 v228, v162, v162, v244
    v_perm_b32 v229, v162, v162, v245
    v_perm_b32 v230, v162, v162, v246
    v_perm_b32 v231, v162, v162, v247
    v_mfma_f32_16x16x32_bf16 v[28:31], v[224:227], a[16:19], v[28:31]
    v_perm_b32 v232, v163, v163, v240
    v_perm_b32 v233, v163, v163, v241
    v_perm_b32 v234, v163, v163, v242
    v_perm_b32 v235, v163, v163, v243
    v_mfma_f32_16x16x32_bf16 v[28:31], v[228:231], a[20:23], v[28:31]
    v_perm_b32 v236, v163, v163, v244
    v_perm_b32 v237, v163, v163, v245
    v_perm_b32 v238, v163, v163, v246
    v_perm_b32 v239, v163, v163, v247
    v_mfma_f32_16x16x32_bf16 v[28:31], v[232:235], a[24:27], v[28:31]
    v_perm_b32 v224, v164, v164, v240
    v_perm_b32 v225, v164, v164, v241
    v_perm_b32 v226, v164, v164, v242
    v_perm_b32 v227, v164, v164, v243
    v_mfma_f32_16x16x32_bf16 v[28:31], v[236:239], a[28:31], v[28:31]
    v_perm_b32 v228, v164, v164, v244
    v_perm_b32 v229, v164, v164, v245
    v_perm_b32 v230, v164, v164, v246
    v_perm_b32 v231, v164, v164, v247
    v_mfma_f32_16x16x32_bf16 v[28:31], v[224:227], a[32:35], v[28:31]
    v_perm_b32 v232, v165, v165, v240
    v_perm_b32 v233, v165, v165, v241
    v_perm_b32 v234, v165, v165, v242
    v_perm_b32 v235, v165, v165, v243
    v_mfma_f32_16x16x32_bf16 v[28:31], v[228:231], a[36:39], v[28:31]
    v_perm_b32 v236, v165, v165, v244
    v_perm_b32 v237, v165, v165, v245
    v_perm_b32 v238, v165, v165, v246
    v_perm_b32 v239, v165, v165, v247
    v_mfma_f32_16x16x32_bf16 v[28:31], v[232:235], a[40:43], v[28:31]
    v_perm_b32 v224, v166, v166, v240
    v_perm_b32 v225, v166, v166, v241
    v_perm_b32 v226, v166, v166, v242
    v_perm_b32 v227, v166, v166, v243
    v_mfma_f32_16x16x32_bf16 v[28:31], v[236:239], a[44:47], v[28:31]
    v_perm_b32 v228, v166, v166, v244
    v_perm_b32 v229, v166, v166, v245
    v_perm_b32 v230, v166, v166, v246
    v_perm_b32 v231, v166, v166, v247
    v_mfma_f32_16x16x32_bf16 v[28:31], v[224:227], a[48:51], v[28:31]
    v_perm_b32 v232, v167, v167, v240
    v_perm_b32 v233, v167, v167, v241
    v_perm_b32 v234, v167, v167, v242
    v_perm_b32 v235, v167, v167, v243
    v_mfma_f32_16x16x32_bf16 v[28:31], v[228:231], a[52:55], v[28:31]
    v_perm_b32 v236, v167, v167, v244
    v_perm_b32 v237, v167, v167, v245
    v_perm_b32 v238, v167, v167, v246
    v_perm_b32 v239, v167, v167, v247
    v_mfma_f32_16x16x32_bf16 v[28:31], v[232:235], a[56:59], v[28:31]
    v_perm_b32 v224, v168, v168, v240
    v_perm_b32 v225, v168, v168, v241
    v_perm_b32 v226, v168, v168, v242
    v_perm_b32 v227, v168, v168, v243
    v_mfma_f32_16x16x32_bf16 v[28:31], v[236:239], a[60:63], v[28:31]
    v_perm_b32 v228, v168, v168, v244
    v_perm_b32 v229, v168, v168, v245
    v_perm_b32 v230, v168, v168, v246
    v_perm_b32 v231, v168, v168, v247
    v_mfma_f32_16x16x32_bf16 v[28:31], v[224:227], a[64:67], v[28:31]
    v_perm_b32 v232, v169, v169, v240
    v_perm_b32 v233, v169, v169, v241
    v_perm_b32 v234, v169, v169, v242
    v_perm_b32 v235, v169, v169, v243
    v_mfma_f32_16x16x32_bf16 v[28:31], v[228:231], a[68:71], v[28:31]
    v_perm_b32 v236, v169, v169, v244
    v_perm_b32 v237, v169, v169, v245
    v_perm_b32 v238, v169, v169, v246
    v_perm_b32 v239, v169, v169, v247
    v_mfma_f32_16x16x32_bf16 v[28:31], v[232:235], a[72:75], v[28:31]
    v_perm_b32 v224, v170, v170, v240
    v_perm_b32 v225, v170, v170, v241
    v_perm_b32 v226, v170, v170, v242
    v_perm_b32 v227, v170, v170, v243
    v_mfma_f32_16x16x32_bf16 v[28:31], v[236:239], a[76:79], v[28:31]
    v_perm_b32 v228, v170, v170, v244
    v_perm_b32 v229, v170, v170, v245
    v_perm_b32 v230, v170, v170, v246
    v_perm_b32 v231, v170, v170, v247
    v_mfma_f32_16x16x32_bf16 v[28:31], v[224:227], a[80:83], v[28:31]
    v_perm_b32 v232, v171, v171, v240
    v_perm_b32 v233, v171, v171, v241
    v_perm_b32 v234, v171, v171, v242
    v_perm_b32 v235, v171, v171, v243
    v_mfma_f32_16x16x32_bf16 v[28:31], v[228:231], a[84:87], v[28:31]
    v_perm_b32 v236, v171, v171, v244
    v_perm_b32 v237, v171, v171, v245
    v_perm_b32 v238, v171, v171, v246
    v_perm_b32 v239, v171, v171, v247
    v_mfma_f32_16x16x32_bf16 v[28:31], v[232:235], a[88:91], v[28:31]
    v_perm_b32 v224, v172, v172, v240
    v_perm_b32 v225, v172, v172, v241
    v_perm_b32 v226, v172, v172, v242
    v_perm_b32 v227, v172, v172, v243
    v_mfma_f32_16x16x32_bf16 v[28:31], v[236:239], a[92:95], v[28:31]
    v_perm_b32 v228, v172, v172, v244
    v_perm_b32 v229, v172, v172, v245
    v_perm_b32 v230, v172, v172, v246
    v_perm_b32 v231, v172, v172, v247
    v_mfma_f32_16x16x32_bf16 v[28:31], v[224:227], a[96:99], v[28:31]
    v_perm_b32 v232, v173, v173, v240
    v_perm_b32 v233, v173, v173, v241
    v_perm_b32 v234, v173, v173, v242
    v_perm_b32 v235, v173, v173, v243
    v_mfma_f32_16x16x32_bf16 v[28:31], v[228:231], a[100:103], v[28:31]
    v_perm_b32 v236, v173, v173, v244
    v_perm_b32 v237, v173, v173, v245
    v_perm_b32 v238, v173, v173, v246
    v_perm_b32 v239, v173, v173, v247
    v_mfma_f32_16x16x32_bf16 v[28:31], v[232:235], a[104:107], v[28:31]
    v_perm_b32 v224, v174, v174, v240
    v_perm_b32 v225, v174, v174, v241
    v_perm_b32 v226, v174, v174, v242
    v_perm_b32 v227, v174, v174, v243
    v_mfma_f32_16x16x32_bf16 v[28:31], v[236:239], a[108:111], v[28:31]
    v_perm_b32 v228, v174, v174, v244
    v_perm_b32 v229, v174, v174, v245
    v_perm_b32 v230, v174, v174, v246
    v_perm_b32 v231, v174, v174, v247
    v_mfma_f32_16x16x32_bf16 v[28:31], v[224:227], a[112:115], v[28:31]
    v_perm_b32 v232, v175, v175, v240
    v_perm_b32 v233, v175, v175, v241
    v_perm_b32 v234, v175, v175, v242
    v_perm_b32 v235, v175, v175, v243
    v_mfma_f32_16x16x32_bf16 v[28:31], v[228:231], a[116:119], v[28:31]
    v_perm_b32 v236, v175, v175, v244
    v_perm_b32 v237, v175, v175, v245
    v_perm_b32 v238, v175, v175, v246
    v_perm_b32 v239, v175, v175, v247
    v_mfma_f32_16x16x32_bf16 v[28:31], v[232:235], a[120:123], v[28:31]
    s_nop 1
    v_mfma_f32_16x16x32_bf16 v[28:31], v[236:239], a[124:127], v[28:31]
    s_mov_b32 s58, 0x200000
    buffer_load_dwordx4 a[0:3], v61, s[16:19], s58 offen
    s_mov_b32 s58, 0x202000
    buffer_load_dwordx4 a[4:7], v61, s[16:19], s58 offen
    s_mov_b32 s58, 0x204000
    buffer_load_dwordx4 a[8:11], v61, s[16:19], s58 offen
    s_mov_b32 s58, 0x206000
    buffer_load_dwordx4 a[12:15], v61, s[16:19], s58 offen
    s_mov_b32 s58, 0x208000
    buffer_load_dwordx4 a[16:19], v61, s[16:19], s58 offen
    s_mov_b32 s58, 0x20a000
    buffer_load_dwordx4 a[20:23], v61, s[16:19], s58 offen
    s_mov_b32 s58, 0x20c000
    buffer_load_dwordx4 a[24:27], v61, s[16:19], s58 offen
    s_mov_b32 s58, 0x20e000
    buffer_load_dwordx4 a[28:31], v61, s[16:19], s58 offen
    s_mov_b32 s58, 0x210000
    buffer_load_dwordx4 a[32:35], v61, s[16:19], s58 offen
    s_mov_b32 s58, 0x212000
    buffer_load_dwordx4 a[36:39], v61, s[16:19], s58 offen
    s_mov_b32 s58, 0x214000
    buffer_load_dwordx4 a[40:43], v61, s[16:19], s58 offen
    s_mov_b32 s58, 0x216000
    buffer_load_dwordx4 a[44:47], v61, s[16:19], s58 offen
    s_mov_b32 s58, 0x218000
    buffer_load_dwordx4 a[48:51], v61, s[16:19], s58 offen
    s_mov_b32 s58, 0x21a000
    buffer_load_dwordx4 a[52:55], v61, s[16:19], s58 offen
    s_mov_b32 s58, 0x21c000
    buffer_load_dwordx4 a[56:59], v61, s[16:19], s58 offen
    s_mov_b32 s58, 0x21e000
    buffer_load_dwordx4 a[60:63], v61, s[16:19], s58 offen
    s_mov_b32 s58, 0x220000
    buffer_load_dwordx4 a[64:67], v61, s[16:19], s58 offen
    s_mov_b32 s58, 0x222000
    buffer_load_dwordx4 a[68:71], v61, s[16:19], s58 offen
    s_mov_b32 s58, 0x224000
    buffer_load_dwordx4 a[72:75], v61, s[16:19], s58 offen
    s_mov_b32 s58, 0x226000
    buffer_load_dwordx4 a[76:79], v61, s[16:19], s58 offen
    s_mov_b32 s58, 0x228000
    buffer_load_dwordx4 a[80:83], v61, s[16:19], s58 offen
    s_mov_b32 s58, 0x22a000
    buffer_load_dwordx4 a[84:87], v61, s[16:19], s58 offen
    s_mov_b32 s58, 0x22c000
    buffer_load_dwordx4 a[88:91], v61, s[16:19], s58 offen
    s_mov_b32 s58, 0x22e000
    buffer_load_dwordx4 a[92:95], v61, s[16:19], s58 offen
    s_mov_b32 s58, 0x230000
    buffer_load_dwordx4 a[96:99], v61, s[16:19], s58 offen
    s_mov_b32 s58, 0x232000
    buffer_load_dwordx4 a[100:103], v61, s[16:19], s58 offen
    s_mov_b32 s58, 0x234000
    buffer_load_dwordx4 a[104:107], v61, s[16:19], s58 offen
    s_mov_b32 s58, 0x236000
    buffer_load_dwordx4 a[108:111], v61, s[16:19], s58 offen
    s_mov_b32 s58, 0x238000
    buffer_load_dwordx4 a[112:115], v61, s[16:19], s58 offen
    s_mov_b32 s58, 0x23a000
    buffer_load_dwordx4 a[116:119], v61, s[16:19], s58 offen
    s_mov_b32 s58, 0x23c000
    buffer_load_dwordx4 a[120:123], v61, s[16:19], s58 offen
    s_mov_b32 s58, 0x23e000
    buffer_load_dwordx4 a[124:127], v61, s[16:19], s58 offen
    s_waitcnt vmcnt(32)
    v_perm_b32 v224, v176, v176, v240
    v_perm_b32 v225, v176, v176, v241
    v_perm_b32 v226, v176, v176, v242
    v_perm_b32 v227, v176, v176, v243
    v_perm_b32 v228, v176, v176, v244
    v_perm_b32 v229, v176, v176, v245
    v_perm_b32 v230, v176, v176, v246
    v_perm_b32 v231, v176, v176, v247
    v_mfma_f32_16x16x32_bf16 v[28:31], v[224:227], a[128:131], v[28:31]
    v_perm_b32 v232, v177, v177, v240
    v_perm_b32 v233, v177, v177, v241
    v_perm_b32 v234, v177, v177, v242
    v_perm_b32 v235, v177, v177, v243
    v_mfma_f32_16x16x32_bf16 v[28:31], v[228:231], a[132:135], v[28:31]
    v_perm_b32 v236, v177, v177, v244
    v_perm_b32 v237, v177, v177, v245
    v_perm_b32 v238, v177, v177, v246
    v_perm_b32 v239, v177, v177, v247
    v_mfma_f32_16x16x32_bf16 v[28:31], v[232:235], a[136:139], v[28:31]
    v_perm_b32 v224, v178, v178, v240
    v_perm_b32 v225, v178, v178, v241
    v_perm_b32 v226, v178, v178, v242
    v_perm_b32 v227, v178, v178, v243
    v_mfma_f32_16x16x32_bf16 v[28:31], v[236:239], a[140:143], v[28:31]
    v_perm_b32 v228, v178, v178, v244
    v_perm_b32 v229, v178, v178, v245
    v_perm_b32 v230, v178, v178, v246
    v_perm_b32 v231, v178, v178, v247
    v_mfma_f32_16x16x32_bf16 v[28:31], v[224:227], a[144:147], v[28:31]
    v_perm_b32 v232, v179, v179, v240
    v_perm_b32 v233, v179, v179, v241
    v_perm_b32 v234, v179, v179, v242
    v_perm_b32 v235, v179, v179, v243
    v_mfma_f32_16x16x32_bf16 v[28:31], v[228:231], a[148:151], v[28:31]
    v_perm_b32 v236, v179, v179, v244
    v_perm_b32 v237, v179, v179, v245
    v_perm_b32 v238, v179, v179, v246
    v_perm_b32 v239, v179, v179, v247
    v_mfma_f32_16x16x32_bf16 v[28:31], v[232:235], a[152:155], v[28:31]
    v_perm_b32 v224, v180, v180, v240
    v_perm_b32 v225, v180, v180, v241
    v_perm_b32 v226, v180, v180, v242
    v_perm_b32 v227, v180, v180, v243
    v_mfma_f32_16x16x32_bf16 v[28:31], v[236:239], a[156:159], v[28:31]
    v_perm_b32 v228, v180, v180, v244
    v_perm_b32 v229, v180, v180, v245
    v_perm_b32 v230, v180, v180, v246
    v_perm_b32 v231, v180, v180, v247
    v_mfma_f32_16x16x32_bf16 v[28:31], v[224:227], a[160:163], v[28:31]
    v_perm_b32 v232, v181, v181, v240
    v_perm_b32 v233, v181, v181, v241
    v_perm_b32 v234, v181, v181, v242
    v_perm_b32 v235, v181, v181, v243
    v_mfma_f32_16x16x32_bf16 v[28:31], v[228:231], a[164:167], v[28:31]
    v_perm_b32 v236, v181, v181, v244
    v_perm_b32 v237, v181, v181, v245
    v_perm_b32 v238, v181, v181, v246
    v_perm_b32 v239, v181, v181, v247
    v_mfma_f32_16x16x32_bf16 v[28:31], v[232:235], a[168:171], v[28:31]
    v_perm_b32 v224, v182, v182, v240
    v_perm_b32 v225, v182, v182, v241
    v_perm_b32 v226, v182, v182, v242
    v_perm_b32 v227, v182, v182, v243
    v_mfma_f32_16x16x32_bf16 v[28:31], v[236:239], a[172:175], v[28:31]
    v_perm_b32 v228, v182, v182, v244
    v_perm_b32 v229, v182, v182, v245
    v_perm_b32 v230, v182, v182, v246
    v_perm_b32 v231, v182, v182, v247
    v_mfma_f32_16x16x32_bf16 v[28:31], v[224:227], a[176:179], v[28:31]
    v_perm_b32 v232, v183, v183, v240
    v_perm_b32 v233, v183, v183, v241
    v_perm_b32 v234, v183, v183, v242
    v_perm_b32 v235, v183, v183, v243
    v_mfma_f32_16x16x32_bf16 v[28:31], v[228:231], a[180:183], v[28:31]
    v_perm_b32 v236, v183, v183, v244
    v_perm_b32 v237, v183, v183, v245
    v_perm_b32 v238, v183, v183, v246
    v_perm_b32 v239, v183, v183, v247
    v_mfma_f32_16x16x32_bf16 v[28:31], v[232:235], a[184:187], v[28:31]
    v_perm_b32 v224, v184, v184, v240
    v_perm_b32 v225, v184, v184, v241
    v_perm_b32 v226, v184, v184, v242
    v_perm_b32 v227, v184, v184, v243
    v_mfma_f32_16x16x32_bf16 v[28:31], v[236:239], a[188:191], v[28:31]
    v_perm_b32 v228, v184, v184, v244
    v_perm_b32 v229, v184, v184, v245
    v_perm_b32 v230, v184, v184, v246
    v_perm_b32 v231, v184, v184, v247
    v_mfma_f32_16x16x32_bf16 v[28:31], v[224:227], a[192:195], v[28:31]
    v_perm_b32 v232, v185, v185, v240
    v_perm_b32 v233, v185, v185, v241
    v_perm_b32 v234, v185, v185, v242
    v_perm_b32 v235, v185, v185, v243
    v_mfma_f32_16x16x32_bf16 v[28:31], v[228:231], a[196:199], v[28:31]
    v_perm_b32 v236, v185, v185, v244
    v_perm_b32 v237, v185, v185, v245
    v_perm_b32 v238, v185, v185, v246
    v_perm_b32 v239, v185, v185, v247
    v_mfma_f32_16x16x32_bf16 v[28:31], v[232:235], a[200:203], v[28:31]
    v_perm_b32 v224, v186, v186, v240
    v_perm_b32 v225, v186, v186, v241
    v_perm_b32 v226, v186, v186, v242
    v_perm_b32 v227, v186, v186, v243
    v_mfma_f32_16x16x32_bf16 v[28:31], v[236:239], a[204:207], v[28:31]
    v_perm_b32 v228, v186, v186, v244
    v_perm_b32 v229, v186, v186, v245
    v_perm_b32 v230, v186, v186, v246
    v_perm_b32 v231, v186, v186, v247
    v_mfma_f32_16x16x32_bf16 v[28:31], v[224:227], a[208:211], v[28:31]
    v_perm_b32 v232, v187, v187, v240
    v_perm_b32 v233, v187, v187, v241
    v_perm_b32 v234, v187, v187, v242
    v_perm_b32 v235, v187, v187, v243
    v_mfma_f32_16x16x32_bf16 v[28:31], v[228:231], a[212:215], v[28:31]
    v_perm_b32 v236, v187, v187, v244
    v_perm_b32 v237, v187, v187, v245
    v_perm_b32 v238, v187, v187, v246
    v_perm_b32 v239, v187, v187, v247
    v_mfma_f32_16x16x32_bf16 v[28:31], v[232:235], a[216:219], v[28:31]
    v_perm_b32 v224, v188, v188, v240
    v_perm_b32 v225, v188, v188, v241
    v_perm_b32 v226, v188, v188, v242
    v_perm_b32 v227, v188, v188, v243
    v_mfma_f32_16x16x32_bf16 v[28:31], v[236:239], a[220:223], v[28:31]
    v_perm_b32 v228, v188, v188, v244
    v_perm_b32 v229, v188, v188, v245
    v_perm_b32 v230, v188, v188, v246
    v_perm_b32 v231, v188, v188, v247
    v_mfma_f32_16x16x32_bf16 v[28:31], v[224:227], a[224:227], v[28:31]
    v_perm_b32 v232, v189, v189, v240
    v_perm_b32 v233, v189, v189, v241
    v_perm_b32 v234, v189, v189, v242
    v_perm_b32 v235, v189, v189, v243
    v_mfma_f32_16x16x32_bf16 v[28:31], v[228:231], a[228:231], v[28:31]
    v_perm_b32 v236, v189, v189, v244
    v_perm_b32 v237, v189, v189, v245
    v_perm_b32 v238, v189, v189, v246
    v_perm_b32 v239, v189, v189, v247
    v_mfma_f32_16x16x32_bf16 v[28:31], v[232:235], a[232:235], v[28:31]
    v_perm_b32 v224, v190, v190, v240
    v_perm_b32 v225, v190, v190, v241
    v_perm_b32 v226, v190, v190, v242
    v_perm_b32 v227, v190, v190, v243
    v_mfma_f32_16x16x32_bf16 v[28:31], v[236:239], a[236:239], v[28:31]
    v_perm_b32 v228, v190, v190, v244
    v_perm_b32 v229, v190, v190, v245
    v_perm_b32 v230, v190, v190, v246
    v_perm_b32 v231, v190, v190, v247
    v_mfma_f32_16x16x32_bf16 v[28:31], v[224:227], a[240:243], v[28:31]
    v_perm_b32 v232, v191, v191, v240
    v_perm_b32 v233, v191, v191, v241
    v_perm_b32 v234, v191, v191, v242
    v_perm_b32 v235, v191, v191, v243
    v_mfma_f32_16x16x32_bf16 v[28:31], v[228:231], a[244:247], v[28:31]
    v_perm_b32 v236, v191, v191, v244
    v_perm_b32 v237, v191, v191, v245
    v_perm_b32 v238, v191, v191, v246
    v_perm_b32 v239, v191, v191, v247
    v_mfma_f32_16x16x32_bf16 v[28:31], v[232:235], a[248:251], v[28:31]
    s_nop 1
    v_mfma_f32_16x16x32_bf16 v[28:31], v[236:239], a[252:255], v[28:31]
    s_mov_b32 s58, 0x300000
    buffer_load_dwordx4 a[128:131], v61, s[16:19], s58 offen
    s_mov_b32 s58, 0x302000
    buffer_load_dwordx4 a[132:135], v61, s[16:19], s58 offen
    s_mov_b32 s58, 0x304000
    buffer_load_dwordx4 a[136:139], v61, s[16:19], s58 offen
    s_mov_b32 s58, 0x306000
    buffer_load_dwordx4 a[140:143], v61, s[16:19], s58 offen
    s_mov_b32 s58, 0x308000
    buffer_load_dwordx4 a[144:147], v61, s[16:19], s58 offen
    s_mov_b32 s58, 0x30a000
    buffer_load_dwordx4 a[148:151], v61, s[16:19], s58 offen
    s_mov_b32 s58, 0x30c000
    buffer_load_dwordx4 a[152:155], v61, s[16:19], s58 offen
    s_mov_b32 s58, 0x30e000
    buffer_load_dwordx4 a[156:159], v61, s[16:19], s58 offen
    s_mov_b32 s58, 0x310000
    buffer_load_dwordx4 a[160:163], v61, s[16:19], s58 offen
    s_mov_b32 s58, 0x312000
    buffer_load_dwordx4 a[164:167], v61, s[16:19], s58 offen
    s_mov_b32 s58, 0x314000
    buffer_load_dwordx4 a[168:171], v61, s[16:19], s58 offen
    s_mov_b32 s58, 0x316000
    buffer_load_dwordx4 a[172:175], v61, s[16:19], s58 offen
    s_mov_b32 s58, 0x318000
    buffer_load_dwordx4 a[176:179], v61, s[16:19], s58 offen
    s_mov_b32 s58, 0x31a000
    buffer_load_dwordx4 a[180:183], v61, s[16:19], s58 offen
    s_mov_b32 s58, 0x31c000
    buffer_load_dwordx4 a[184:187], v61, s[16:19], s58 offen
    s_mov_b32 s58, 0x31e000
    buffer_load_dwordx4 a[188:191], v61, s[16:19], s58 offen
    s_mov_b32 s58, 0x320000
    buffer_load_dwordx4 a[192:195], v61, s[16:19], s58 offen
    s_mov_b32 s58, 0x322000
    buffer_load_dwordx4 a[196:199], v61, s[16:19], s58 offen
    s_mov_b32 s58, 0x324000
    buffer_load_dwordx4 a[200:203], v61, s[16:19], s58 offen
    s_mov_b32 s58, 0x326000
    buffer_load_dwordx4 a[204:207], v61, s[16:19], s58 offen
    s_mov_b32 s58, 0x328000
    buffer_load_dwordx4 a[208:211], v61, s[16:19], s58 offen
    s_mov_b32 s58, 0x32a000
    buffer_load_dwordx4 a[212:215], v61, s[16:19], s58 offen
    s_mov_b32 s58, 0x32c000
    buffer_load_dwordx4 a[216:219], v61, s[16:19], s58 offen
    s_mov_b32 s58, 0x32e000
    buffer_load_dwordx4 a[220:223], v61, s[16:19], s58 offen
    s_mov_b32 s58, 0x330000
    buffer_load_dwordx4 a[224:227], v61, s[16:19], s58 offen
    s_mov_b32 s58, 0x332000
    buffer_load_dwordx4 a[228:231], v61, s[16:19], s58 offen
    s_mov_b32 s58, 0x334000
    buffer_load_dwordx4 a[232:235], v61, s[16:19], s58 offen
    s_mov_b32 s58, 0x336000
    buffer_load_dwordx4 a[236:239], v61, s[16:19], s58 offen
    s_mov_b32 s58, 0x338000
    buffer_load_dwordx4 a[240:243], v61, s[16:19], s58 offen
    s_mov_b32 s58, 0x33a000
    buffer_load_dwordx4 a[244:247], v61, s[16:19], s58 offen
    s_mov_b32 s58, 0x33c000
    buffer_load_dwordx4 a[248:251], v61, s[16:19], s58 offen
    s_mov_b32 s58, 0x33e000
    buffer_load_dwordx4 a[252:255], v61, s[16:19], s58 offen
    s_waitcnt vmcnt(32)
    v_perm_b32 v224, v192, v192, v240
    v_perm_b32 v225, v192, v192, v241
    v_perm_b32 v226, v192, v192, v242
    v_perm_b32 v227, v192, v192, v243
    v_perm_b32 v228, v192, v192, v244
    v_perm_b32 v229, v192, v192, v245
    v_perm_b32 v230, v192, v192, v246
    v_perm_b32 v231, v192, v192, v247
    v_mfma_f32_16x16x32_bf16 v[28:31], v[224:227], a[0:3], v[28:31]
    v_perm_b32 v232, v193, v193, v240
    v_perm_b32 v233, v193, v193, v241
    v_perm_b32 v234, v193, v193, v242
    v_perm_b32 v235, v193, v193, v243
    v_mfma_f32_16x16x32_bf16 v[28:31], v[228:231], a[4:7], v[28:31]
    v_perm_b32 v236, v193, v193, v244
    v_perm_b32 v237, v193, v193, v245
    v_perm_b32 v238, v193, v193, v246
    v_perm_b32 v239, v193, v193, v247
    v_mfma_f32_16x16x32_bf16 v[28:31], v[232:235], a[8:11], v[28:31]
    v_perm_b32 v224, v194, v194, v240
    v_perm_b32 v225, v194, v194, v241
    v_perm_b32 v226, v194, v194, v242
    v_perm_b32 v227, v194, v194, v243
    v_mfma_f32_16x16x32_bf16 v[28:31], v[236:239], a[12:15], v[28:31]
    v_perm_b32 v228, v194, v194, v244
    v_perm_b32 v229, v194, v194, v245
    v_perm_b32 v230, v194, v194, v246
    v_perm_b32 v231, v194, v194, v247
    v_mfma_f32_16x16x32_bf16 v[28:31], v[224:227], a[16:19], v[28:31]
    v_perm_b32 v232, v195, v195, v240
    v_perm_b32 v233, v195, v195, v241
    v_perm_b32 v234, v195, v195, v242
    v_perm_b32 v235, v195, v195, v243
    v_mfma_f32_16x16x32_bf16 v[28:31], v[228:231], a[20:23], v[28:31]
    v_perm_b32 v236, v195, v195, v244
    v_perm_b32 v237, v195, v195, v245
    v_perm_b32 v238, v195, v195, v246
    v_perm_b32 v239, v195, v195, v247
    v_mfma_f32_16x16x32_bf16 v[28:31], v[232:235], a[24:27], v[28:31]
    v_perm_b32 v224, v196, v196, v240
    v_perm_b32 v225, v196, v196, v241
    v_perm_b32 v226, v196, v196, v242
    v_perm_b32 v227, v196, v196, v243
    v_mfma_f32_16x16x32_bf16 v[28:31], v[236:239], a[28:31], v[28:31]
    v_perm_b32 v228, v196, v196, v244
    v_perm_b32 v229, v196, v196, v245
    v_perm_b32 v230, v196, v196, v246
    v_perm_b32 v231, v196, v196, v247
    v_mfma_f32_16x16x32_bf16 v[28:31], v[224:227], a[32:35], v[28:31]
    v_perm_b32 v232, v197, v197, v240
    v_perm_b32 v233, v197, v197, v241
    v_perm_b32 v234, v197, v197, v242
    v_perm_b32 v235, v197, v197, v243
    v_mfma_f32_16x16x32_bf16 v[28:31], v[228:231], a[36:39], v[28:31]
    v_perm_b32 v236, v197, v197, v244
    v_perm_b32 v237, v197, v197, v245
    v_perm_b32 v238, v197, v197, v246
    v_perm_b32 v239, v197, v197, v247
    v_mfma_f32_16x16x32_bf16 v[28:31], v[232:235], a[40:43], v[28:31]
    v_perm_b32 v224, v198, v198, v240
    v_perm_b32 v225, v198, v198, v241
    v_perm_b32 v226, v198, v198, v242
    v_perm_b32 v227, v198, v198, v243
    v_mfma_f32_16x16x32_bf16 v[28:31], v[236:239], a[44:47], v[28:31]
    v_perm_b32 v228, v198, v198, v244
    v_perm_b32 v229, v198, v198, v245
    v_perm_b32 v230, v198, v198, v246
    v_perm_b32 v231, v198, v198, v247
    v_mfma_f32_16x16x32_bf16 v[28:31], v[224:227], a[48:51], v[28:31]
    v_perm_b32 v232, v199, v199, v240
    v_perm_b32 v233, v199, v199, v241
    v_perm_b32 v234, v199, v199, v242
    v_perm_b32 v235, v199, v199, v243
    v_mfma_f32_16x16x32_bf16 v[28:31], v[228:231], a[52:55], v[28:31]
    v_perm_b32 v236, v199, v199, v244
    v_perm_b32 v237, v199, v199, v245
    v_perm_b32 v238, v199, v199, v246
    v_perm_b32 v239, v199, v199, v247
    v_mfma_f32_16x16x32_bf16 v[28:31], v[232:235], a[56:59], v[28:31]
    v_perm_b32 v224, v200, v200, v240
    v_perm_b32 v225, v200, v200, v241
    v_perm_b32 v226, v200, v200, v242
    v_perm_b32 v227, v200, v200, v243
    v_mfma_f32_16x16x32_bf16 v[28:31], v[236:239], a[60:63], v[28:31]
    v_perm_b32 v228, v200, v200, v244
    v_perm_b32 v229, v200, v200, v245
    v_perm_b32 v230, v200, v200, v246
    v_perm_b32 v231, v200, v200, v247
    v_mfma_f32_16x16x32_bf16 v[28:31], v[224:227], a[64:67], v[28:31]
    v_perm_b32 v232, v201, v201, v240
    v_perm_b32 v233, v201, v201, v241
    v_perm_b32 v234, v201, v201, v242
    v_perm_b32 v235, v201, v201, v243
    v_mfma_f32_16x16x32_bf16 v[28:31], v[228:231], a[68:71], v[28:31]
    v_perm_b32 v236, v201, v201, v244
    v_perm_b32 v237, v201, v201, v245
    v_perm_b32 v238, v201, v201, v246
    v_perm_b32 v239, v201, v201, v247
    v_mfma_f32_16x16x32_bf16 v[28:31], v[232:235], a[72:75], v[28:31]
    v_perm_b32 v224, v202, v202, v240
    v_perm_b32 v225, v202, v202, v241
    v_perm_b32 v226, v202, v202, v242
    v_perm_b32 v227, v202, v202, v243
    v_mfma_f32_16x16x32_bf16 v[28:31], v[236:239], a[76:79], v[28:31]
    v_perm_b32 v228, v202, v202, v244
    v_perm_b32 v229, v202, v202, v245
    v_perm_b32 v230, v202, v202, v246
    v_perm_b32 v231, v202, v202, v247
    v_mfma_f32_16x16x32_bf16 v[28:31], v[224:227], a[80:83], v[28:31]
    v_perm_b32 v232, v203, v203, v240
    v_perm_b32 v233, v203, v203, v241
    v_perm_b32 v234, v203, v203, v242
    v_perm_b32 v235, v203, v203, v243
    v_mfma_f32_16x16x32_bf16 v[28:31], v[228:231], a[84:87], v[28:31]
    v_perm_b32 v236, v203, v203, v244
    v_perm_b32 v237, v203, v203, v245
    v_perm_b32 v238, v203, v203, v246
    v_perm_b32 v239, v203, v203, v247
    v_mfma_f32_16x16x32_bf16 v[28:31], v[232:235], a[88:91], v[28:31]
    v_perm_b32 v224, v204, v204, v240
    v_perm_b32 v225, v204, v204, v241
    v_perm_b32 v226, v204, v204, v242
    v_perm_b32 v227, v204, v204, v243
    v_mfma_f32_16x16x32_bf16 v[28:31], v[236:239], a[92:95], v[28:31]
    v_perm_b32 v228, v204, v204, v244
    v_perm_b32 v229, v204, v204, v245
    v_perm_b32 v230, v204, v204, v246
    v_perm_b32 v231, v204, v204, v247
    v_mfma_f32_16x16x32_bf16 v[28:31], v[224:227], a[96:99], v[28:31]
    v_perm_b32 v232, v205, v205, v240
    v_perm_b32 v233, v205, v205, v241
    v_perm_b32 v234, v205, v205, v242
    v_perm_b32 v235, v205, v205, v243
    v_mfma_f32_16x16x32_bf16 v[28:31], v[228:231], a[100:103], v[28:31]
    v_perm_b32 v236, v205, v205, v244
    v_perm_b32 v237, v205, v205, v245
    v_perm_b32 v238, v205, v205, v246
    v_perm_b32 v239, v205, v205, v247
    v_mfma_f32_16x16x32_bf16 v[28:31], v[232:235], a[104:107], v[28:31]
    v_perm_b32 v224, v206, v206, v240
    v_perm_b32 v225, v206, v206, v241
    v_perm_b32 v226, v206, v206, v242
    v_perm_b32 v227, v206, v206, v243
    v_mfma_f32_16x16x32_bf16 v[28:31], v[236:239], a[108:111], v[28:31]
    v_perm_b32 v228, v206, v206, v244
    v_perm_b32 v229, v206, v206, v245
    v_perm_b32 v230, v206, v206, v246
    v_perm_b32 v231, v206, v206, v247
    v_mfma_f32_16x16x32_bf16 v[28:31], v[224:227], a[112:115], v[28:31]
    v_perm_b32 v232, v207, v207, v240
    v_perm_b32 v233, v207, v207, v241
    v_perm_b32 v234, v207, v207, v242
    v_perm_b32 v235, v207, v207, v243
    v_mfma_f32_16x16x32_bf16 v[28:31], v[228:231], a[116:119], v[28:31]
    v_perm_b32 v236, v207, v207, v244
    v_perm_b32 v237, v207, v207, v245
    v_perm_b32 v238, v207, v207, v246
    v_perm_b32 v239, v207, v207, v247
    v_mfma_f32_16x16x32_bf16 v[28:31], v[232:235], a[120:123], v[28:31]
    s_nop 1
    v_mfma_f32_16x16x32_bf16 v[28:31], v[236:239], a[124:127], v[28:31]
    buffer_load_dwordx4 v[64:67], v1, s[8:11], s45 offen offset:0 nt
    buffer_load_dwordx4 v[68:71], v1, s[8:11], s45 offen offset:1024 nt
    buffer_load_dwordx4 v[72:75], v1, s[8:11], s45 offen offset:2048 nt
    buffer_load_dwordx4 v[76:79], v1, s[8:11], s45 offen offset:3072 nt
    buffer_load_dwordx4 v[80:83], v1, s[12:15], s45 offen offset:0 nt
    buffer_load_dwordx4 v[84:87], v1, s[12:15], s45 offen offset:1024 nt
    buffer_load_dwordx4 v[88:91], v1, s[12:15], s45 offen offset:2048 nt
    buffer_load_dwordx4 v[92:95], v1, s[12:15], s45 offen offset:3072 nt
    s_add_u32 s45, s45, 0x4000
    s_cmp_eq_u32 s45, s48
    s_cselect_b32 s10, 0, s10
    s_cselect_b32 s14, 0, s14
    buffer_load_dwordx4 v[96:99], v1, s[8:11], s45 offen offset:0 nt
    buffer_load_dwordx4 v[100:103], v1, s[8:11], s45 offen offset:1024 nt
    buffer_load_dwordx4 v[104:107], v1, s[8:11], s45 offen offset:2048 nt
    buffer_load_dwordx4 v[108:111], v1, s[8:11], s45 offen offset:3072 nt
    buffer_load_dwordx4 v[112:115], v1, s[12:15], s45 offen offset:0 nt
    buffer_load_dwordx4 v[116:119], v1, s[12:15], s45 offen offset:1024 nt
    buffer_load_dwordx4 v[120:123], v1, s[12:15], s45 offen offset:2048 nt
    buffer_load_dwordx4 v[124:127], v1, s[12:15], s45 offen offset:3072 nt
    s_add_u32 s45, s45, 0x4000
    s_cmp_eq_u32 s45, s48
    s_cselect_b32 s10, 0, s10
    s_cselect_b32 s14, 0, s14
    s_waitcnt vmcnt(16)
    v_perm_b32 v224, v208, v208, v240
    v_perm_b32 v225, v208, v208, v241
    v_perm_b32 v226, v208, v208, v242
    v_perm_b32 v227, v208, v208, v243
    v_perm_b32 v228, v208, v208, v244
    v_perm_b32 v229, v208, v208, v245
    v_perm_b32 v230, v208, v208, v246
    v_perm_b32 v231, v208, v208, v247
    v_mfma_f32_16x16x32_bf16 v[28:31], v[224:227], a[128:131], v[28:31]
    v_perm_b32 v232, v209, v209, v240
    v_perm_b32 v233, v209, v209, v241
    v_perm_b32 v234, v209, v209, v242
    v_perm_b32 v235, v209, v209, v243
    v_mfma_f32_16x16x32_bf16 v[28:31], v[228:231], a[132:135], v[28:31]
    v_perm_b32 v236, v209, v209, v244
    v_perm_b32 v237, v209, v209, v245
    v_perm_b32 v238, v209, v209, v246
    v_perm_b32 v239, v209, v209, v247
    v_mfma_f32_16x16x32_bf16 v[28:31], v[232:235], a[136:139], v[28:31]
    v_perm_b32 v224, v210, v210, v240
    v_perm_b32 v225, v210, v210, v241
    v_perm_b32 v226, v210, v210, v242
    v_perm_b32 v227, v210, v210, v243
    v_mfma_f32_16x16x32_bf16 v[28:31], v[236:239], a[140:143], v[28:31]
    v_perm_b32 v228, v210, v210, v244
    v_perm_b32 v229, v210, v210, v245
    v_perm_b32 v230, v210, v210, v246
    v_perm_b32 v231, v210, v210, v247
    v_mfma_f32_16x16x32_bf16 v[28:31], v[224:227], a[144:147], v[28:31]
    v_perm_b32 v232, v211, v211, v240
    v_perm_b32 v233, v211, v211, v241
    v_perm_b32 v234, v211, v211, v242
    v_perm_b32 v235, v211, v211, v243
    v_mfma_f32_16x16x32_bf16 v[28:31], v[228:231], a[148:151], v[28:31]
    v_perm_b32 v236, v211, v211, v244
    v_perm_b32 v237, v211, v211, v245
    v_perm_b32 v238, v211, v211, v246
    v_perm_b32 v239, v211, v211, v247
    v_mfma_f32_16x16x32_bf16 v[28:31], v[232:235], a[152:155], v[28:31]
    v_perm_b32 v224, v212, v212, v240
    v_perm_b32 v225, v212, v212, v241
    v_perm_b32 v226, v212, v212, v242
    v_perm_b32 v227, v212, v212, v243
    v_mfma_f32_16x16x32_bf16 v[28:31], v[236:239], a[156:159], v[28:31]
    v_perm_b32 v228, v212, v212, v244
    v_perm_b32 v229, v212, v212, v245
    v_perm_b32 v230, v212, v212, v246
    v_perm_b32 v231, v212, v212, v247
    v_mfma_f32_16x16x32_bf16 v[28:31], v[224:227], a[160:163], v[28:31]
    v_perm_b32 v232, v213, v213, v240
    v_perm_b32 v233, v213, v213, v241
    v_perm_b32 v234, v213, v213, v242
    v_perm_b32 v235, v213, v213, v243
    v_mfma_f32_16x16x32_bf16 v[28:31], v[228:231], a[164:167], v[28:31]
    v_perm_b32 v236, v213, v213, v244
    v_perm_b32 v237, v213, v213, v245
    v_perm_b32 v238, v213, v213, v246
    v_perm_b32 v239, v213, v213, v247
    v_mfma_f32_16x16x32_bf16 v[28:31], v[232:235], a[168:171], v[28:31]
    v_perm_b32 v224, v214, v214, v240
    v_perm_b32 v225, v214, v214, v241
    v_perm_b32 v226, v214, v214, v242
    v_perm_b32 v227, v214, v214, v243
    v_mfma_f32_16x16x32_bf16 v[28:31], v[236:239], a[172:175], v[28:31]
    v_perm_b32 v228, v214, v214, v244
    v_perm_b32 v229, v214, v214, v245
    v_perm_b32 v230, v214, v214, v246
    v_perm_b32 v231, v214, v214, v247
    v_mfma_f32_16x16x32_bf16 v[28:31], v[224:227], a[176:179], v[28:31]
    v_perm_b32 v232, v215, v215, v240
    v_perm_b32 v233, v215, v215, v241
    v_perm_b32 v234, v215, v215, v242
    v_perm_b32 v235, v215, v215, v243
    v_mfma_f32_16x16x32_bf16 v[28:31], v[228:231], a[180:183], v[28:31]
    v_perm_b32 v236, v215, v215, v244
    v_perm_b32 v237, v215, v215, v245
    v_perm_b32 v238, v215, v215, v246
    v_perm_b32 v239, v215, v215, v247
    v_mfma_f32_16x16x32_bf16 v[28:31], v[232:235], a[184:187], v[28:31]
    v_perm_b32 v224, v216, v216, v240
    v_perm_b32 v225, v216, v216, v241
    v_perm_b32 v226, v216, v216, v242
    v_perm_b32 v227, v216, v216, v243
    v_mfma_f32_16x16x32_bf16 v[28:31], v[236:239], a[188:191], v[28:31]
    v_perm_b32 v228, v216, v216, v244
    v_perm_b32 v229, v216, v216, v245
    v_perm_b32 v230, v216, v216, v246
    v_perm_b32 v231, v216, v216, v247
    v_mfma_f32_16x16x32_bf16 v[28:31], v[224:227], a[192:195], v[28:31]
    v_perm_b32 v232, v217, v217, v240
    v_perm_b32 v233, v217, v217, v241
    v_perm_b32 v234, v217, v217, v242
    v_perm_b32 v235, v217, v217, v243
    v_mfma_f32_16x16x32_bf16 v[28:31], v[228:231], a[196:199], v[28:31]
    v_perm_b32 v236, v217, v217, v244
    v_perm_b32 v237, v217, v217, v245
    v_perm_b32 v238, v217, v217, v246
    v_perm_b32 v239, v217, v217, v247
    v_mfma_f32_16x16x32_bf16 v[28:31], v[232:235], a[200:203], v[28:31]
    v_perm_b32 v224, v218, v218, v240
    v_perm_b32 v225, v218, v218, v241
    v_perm_b32 v226, v218, v218, v242
    v_perm_b32 v227, v218, v218, v243
    v_mfma_f32_16x16x32_bf16 v[28:31], v[236:239], a[204:207], v[28:31]
    v_perm_b32 v228, v218, v218, v244
    v_perm_b32 v229, v218, v218, v245
    v_perm_b32 v230, v218, v218, v246
    v_perm_b32 v231, v218, v218, v247
    v_mfma_f32_16x16x32_bf16 v[28:31], v[224:227], a[208:211], v[28:31]
    v_perm_b32 v232, v219, v219, v240
    v_perm_b32 v233, v219, v219, v241
    v_perm_b32 v234, v219, v219, v242
    v_perm_b32 v235, v219, v219, v243
    v_mfma_f32_16x16x32_bf16 v[28:31], v[228:231], a[212:215], v[28:31]
    v_perm_b32 v236, v219, v219, v244
    v_perm_b32 v237, v219, v219, v245
    v_perm_b32 v238, v219, v219, v246
    v_perm_b32 v239, v219, v219, v247
    v_mfma_f32_16x16x32_bf16 v[28:31], v[232:235], a[216:219], v[28:31]
    v_perm_b32 v224, v220, v220, v240
    v_perm_b32 v225, v220, v220, v241
    v_perm_b32 v226, v220, v220, v242
    v_perm_b32 v227, v220, v220, v243
    v_mfma_f32_16x16x32_bf16 v[28:31], v[236:239], a[220:223], v[28:31]
    v_perm_b32 v228, v220, v220, v244
    v_perm_b32 v229, v220, v220, v245
    v_perm_b32 v230, v220, v220, v246
    v_perm_b32 v231, v220, v220, v247
    v_mfma_f32_16x16x32_bf16 v[28:31], v[224:227], a[224:227], v[28:31]
    v_perm_b32 v232, v221, v221, v240
    v_perm_b32 v233, v221, v221, v241
    v_perm_b32 v234, v221, v221, v242
    v_perm_b32 v235, v221, v221, v243
    v_mfma_f32_16x16x32_bf16 v[28:31], v[228:231], a[228:231], v[28:31]
    v_perm_b32 v236, v221, v221, v244
    v_perm_b32 v237, v221, v221, v245
    v_perm_b32 v238, v221, v221, v246
    v_perm_b32 v239, v221, v221, v247
    v_mfma_f32_16x16x32_bf16 v[28:31], v[232:235], a[232:235], v[28:31]
    v_perm_b32 v224, v222, v222, v240
    v_perm_b32 v225, v222, v222, v241
    v_perm_b32 v226, v222, v222, v242
    v_perm_b32 v227, v222, v222, v243
    v_mfma_f32_16x16x32_bf16 v[28:31], v[236:239], a[236:239], v[28:31]
    v_perm_b32 v228, v222, v222, v244
    v_perm_b32 v229, v222, v222, v245
    v_perm_b32 v230, v222, v222, v246
    v_perm_b32 v231, v222, v222, v247
    v_mfma_f32_16x16x32_bf16 v[28:31], v[224:227], a[240:243], v[28:31]
    v_perm_b32 v232, v223, v223, v240
    v_perm_b32 v233, v223, v223, v241
    v_perm_b32 v234, v223, v223, v242
    v_perm_b32 v235, v223, v223, v243
    v_mfma_f32_16x16x32_bf16 v[28:31], v[228:231], a[244:247], v[28:31]
    v_perm_b32 v236, v223, v223, v244
    v_perm_b32 v237, v223, v223, v245
    v_perm_b32 v238, v223, v223, v246
    v_perm_b32 v239, v223, v223, v247
    v_mfma_f32_16x16x32_bf16 v[28:31], v[232:235], a[248:251], v[28:31]
    s_nop 1
    v_mfma_f32_16x16x32_bf16 v[28:31], v[236:239], a[252:255], v[28:31]
    s_lshl_b32 s52, s3, 8
    v_lshl_add_u32 v47, v58, 4, s52
    v_lshl_add_u32 v47, v3, 3, v47
    v_lshlrev_b32 v48, 4, v58
    v_cmp_gt_u32 vcc, 2, v3
    s_nop 3
    v_cvt_pk_bf16_f32 v28, v28, v29
    v_cvt_pk_bf16_f32 v29, v30, v31
    s_and_saveexec_b64 s[60:61], vcc
    ds_write_b64 v47, v[28:29] offset:0
    s_mov_b64 exec, s[60:61]
    s_waitcnt lgkmcnt(0)
    s_barrier
    ds_read_b128 v[4:7], v48 offset:0
    ds_read_b128 v[8:11], v48 offset:256
    ds_read_b128 v[12:15], v48 offset:512
    ds_read_b128 v[16:19], v48 offset:768
    s_mov_b32 s16, s4
    s_mov_b32 s17, s5
    s_mov_b32 s18, 0x400000
    s_mov_b32 s19, 0x20000
    s_mov_b32 s49, 32
    v_lshlrev_b32 v59, 4, v3
    s_waitcnt lgkmcnt(0)
A_TILE_0:
    s_waitcnt vmcnt(12)
    v_dot2_f32_bf16 v160, v64, v4, 0
    v_dot2_f32_bf16 v161, v64, v8, 0
    v_dot2_f32_bf16 v162, v64, v12, 0
    v_dot2_f32_bf16 v163, v64, v16, 0
    v_dot2_f32_bf16 v160, v65, v5, v160
    v_dot2_f32_bf16 v161, v65, v9, v161
    v_dot2_f32_bf16 v162, v65, v13, v162
    v_dot2_f32_bf16 v163, v65, v17, v163
    v_dot2_f32_bf16 v160, v66, v6, v160
    v_dot2_f32_bf16 v161, v66, v10, v161
    v_dot2_f32_bf16 v162, v66, v14, v162
    v_dot2_f32_bf16 v163, v66, v18, v163
    v_dot2_f32_bf16 v160, v67, v7, v160
    v_dot2_f32_bf16 v161, v67, v11, v161
    v_dot2_f32_bf16 v162, v67, v15, v162
    v_dot2_f32_bf16 v163, v67, v19, v163
    v_dot2_f32_bf16 v164, v68, v4, 0
    v_dot2_f32_bf16 v165, v68, v8, 0
    v_dot2_f32_bf16 v166, v68, v12, 0
    v_dot2_f32_bf16 v167, v68, v16, 0
    v_dot2_f32_bf16 v164, v69, v5, v164
    v_dot2_f32_bf16 v165, v69, v9, v165
    v_dot2_f32_bf16 v166, v69, v13, v166
    v_dot2_f32_bf16 v167, v69, v17, v167
    v_dot2_f32_bf16 v164, v70, v6, v164
    v_dot2_f32_bf16 v165, v70, v10, v165
    v_dot2_f32_bf16 v166, v70, v14, v166
    v_dot2_f32_bf16 v167, v70, v18, v167
    v_dot2_f32_bf16 v164, v71, v7, v164
    v_dot2_f32_bf16 v165, v71, v11, v165
    v_dot2_f32_bf16 v166, v71, v15, v166
    v_dot2_f32_bf16 v167, v71, v19, v167
    v_dot2_f32_bf16 v168, v72, v4, 0
    v_dot2_f32_bf16 v169, v72, v8, 0
    v_dot2_f32_bf16 v170, v72, v12, 0
    v_dot2_f32_bf16 v171, v72, v16, 0
    v_dot2_f32_bf16 v168, v73, v5, v168
    v_dot2_f32_bf16 v169, v73, v9, v169
    v_dot2_f32_bf16 v170, v73, v13, v170
    v_dot2_f32_bf16 v171, v73, v17, v171
    v_dot2_f32_bf16 v168, v74, v6, v168
    v_dot2_f32_bf16 v169, v74, v10, v169
    v_dot2_f32_bf16 v170, v74, v14, v170
    v_dot2_f32_bf16 v171, v74, v18, v171
    v_dot2_f32_bf16 v168, v75, v7, v168
    v_dot2_f32_bf16 v169, v75, v11, v169
    v_dot2_f32_bf16 v170, v75, v15, v170
    v_dot2_f32_bf16 v171, v75, v19, v171
    v_dot2_f32_bf16 v172, v76, v4, 0
    v_dot2_f32_bf16 v173, v76, v8, 0
    v_dot2_f32_bf16 v174, v76, v12, 0
    v_dot2_f32_bf16 v175, v76, v16, 0
    v_dot2_f32_bf16 v172, v77, v5, v172
    v_dot2_f32_bf16 v173, v77, v9, v173
    v_dot2_f32_bf16 v174, v77, v13, v174
    v_dot2_f32_bf16 v175, v77, v17, v175
    v_dot2_f32_bf16 v172, v78, v6, v172
    v_dot2_f32_bf16 v173, v78, v10, v173
    v_dot2_f32_bf16 v174, v78, v14, v174
    v_dot2_f32_bf16 v175, v78, v18, v175
    v_dot2_f32_bf16 v172, v79, v7, v172
    v_dot2_f32_bf16 v173, v79, v11, v173
    v_dot2_f32_bf16 v174, v79, v15, v174
    v_dot2_f32_bf16 v175, v79, v19, v175
    buffer_load_dwordx4 v[64:67], v1, s[8:11], s45 offen offset:0 nt
    buffer_load_dwordx4 v[68:71], v1, s[8:11], s45 offen offset:1024 nt
    buffer_load_dwordx4 v[72:75], v1, s[8:11], s45 offen offset:2048 nt
    buffer_load_dwordx4 v[76:79], v1, s[8:11], s45 offen offset:3072 nt
    v_add_f32_dpp v176, v160, v160 row_ror:8 row_mask:0xf bank_mask:0x3
    v_add_f32_dpp v178, v164, v164 row_ror:8 row_mask:0xf bank_mask:0x3
    v_add_f32_dpp v180, v168, v168 row_ror:8 row_mask:0xf bank_mask:0x3
    v_add_f32_dpp v182, v172, v172 row_ror:8 row_mask:0xf bank_mask:0x3
    v_add_f32_dpp v177, v161, v161 row_ror:8 row_mask:0xf bank_mask:0x3
    v_add_f32_dpp v179, v165, v165 row_ror:8 row_mask:0xf bank_mask:0x3
    v_add_f32_dpp v181, v169, v169 row_ror:8 row_mask:0xf bank_mask:0x3
    v_add_f32_dpp v183, v173, v173 row_ror:8 row_mask:0xf bank_mask:0x3
    v_add_f32_dpp v176, v162, v162 row_ror:8 row_mask:0xf bank_mask:0xc
    v_add_f32_dpp v178, v166, v166 row_ror:8 row_mask:0xf bank_mask:0xc
    v_add_f32_dpp v180, v170, v170 row_ror:8 row_mask:0xf bank_mask:0xc
    v_add_f32_dpp v182, v174, v174 row_ror:8 row_mask:0xf bank_mask:0xc
    v_add_f32_dpp v177, v163, v163 row_ror:8 row_mask:0xf bank_mask:0xc
    v_add_f32_dpp v179, v167, v167 row_ror:8 row_mask:0xf bank_mask:0xc
    v_add_f32_dpp v181, v171, v171 row_ror:8 row_mask:0xf bank_mask:0xc
    v_add_f32_dpp v183, v175, v175 row_ror:8 row_mask:0xf bank_mask:0xc
    v_add_f32_dpp v184, v176, v176 row_shl:4 row_mask:0xf bank_mask:0x5
    v_add_f32_dpp v185, v178, v178 row_shl:4 row_mask:0xf bank_mask:0x5
    v_add_f32_dpp v186, v180, v180 row_shl:4 row_mask:0xf bank_mask:0x5
    v_add_f32_dpp v187, v182, v182 row_shl:4 row_mask:0xf bank_mask:0x5
    v_add_f32_dpp v184, v177, v177 row_shr:4 row_mask:0xf bank_mask:0xa
    v_add_f32_dpp v185, v179, v179 row_shr:4 row_mask:0xf bank_mask:0xa
    v_add_f32_dpp v186, v181, v181 row_shr:4 row_mask:0xf bank_mask:0xa
    v_add_f32_dpp v187, v183, v183 row_shr:4 row_mask:0xf bank_mask:0xa
    v_add_f32_dpp v184, v184, v184 quad_perm:[2,3,0,1] row_mask:0xf bank_mask:0xf
    v_add_f32_dpp v185, v185, v185 quad_perm:[2,3,0,1] row_mask:0xf bank_mask:0xf
    v_add_f32_dpp v186, v186, v186 quad_perm:[2,3,0,1] row_mask:0xf bank_mask:0xf
    v_add_f32_dpp v187, v187, v187 quad_perm:[2,3,0,1] row_mask:0xf bank_mask:0xf
    v_add_f32_dpp v184, v184, v184 quad_perm:[1,0,3,2] row_mask:0xf bank_mask:0xf
    v_add_f32_dpp v185, v185, v185 quad_perm:[1,0,3,2] row_mask:0xf bank_mask:0xf
    v_add_f32_dpp v186, v186, v186 quad_perm:[1,0,3,2] row_mask:0xf bank_mask:0xf
    v_add_f32_dpp v187, v187, v187 quad_perm:[1,0,3,2] row_mask:0xf bank_mask:0xf
    v_cvt_pk_bf16_f32 v184, v184, v184
    v_cvt_pk_bf16_f32 v185, v185, v185
    v_cvt_pk_bf16_f32 v186, v186, v186
    v_cvt_pk_bf16_f32 v187, v187, v187
    v_and_b32 v184, s56, v184
    v_and_b32 v185, s56, v185
    v_and_b32 v186, s56, v186
    v_and_b32 v187, s56, v187
    v_mul_f32 v184, s55, v184
    v_mul_f32 v185, s55, v185
    v_mul_f32 v186, s55, v186
    v_mul_f32 v187, s55, v187
    v_cvt_pk_bf16_f32 v184, v184, v184
    v_cvt_pk_bf16_f32 v185, v185, v185
    v_cvt_pk_bf16_f32 v186, v186, v186
    v_cvt_pk_bf16_f32 v187, v187, v187
    v_and_b32 v184, s56, v184
    v_and_b32 v185, s56, v185
    v_and_b32 v186, s56, v186
    v_and_b32 v187, s56, v187
    v_fma_f32 v188, v184, s54, -v38
    v_fma_f32 v189, v185, s54, -v38
    v_fma_f32 v190, v186, s54, -v38
    v_fma_f32 v191, v187, s54, -v38
    v_max3_f32 v47, v188, v189, v190
    v_max_f32 v47, v47, v191
    v_cmp_lt_f32 vcc, 0, v47
    s_cbranch_vccnz A_SLOW_0
A_CONT_0:
    v_exp_f32 v188, v188
    v_exp_f32 v189, v189
    v_exp_f32 v190, v190
    v_exp_f32 v191, v191
    v_add_f32 v39, v39, v188
    v_add_f32 v47, v189, v190
    v_add_f32 v39, v39, v191
    v_add_f32 v39, v39, v47
    v_cvt_pk_bf16_f32 v188, v188, v188
    v_cvt_pk_bf16_f32 v189, v189, v189
    v_cvt_pk_bf16_f32 v190, v190, v190
    v_cvt_pk_bf16_f32 v191, v191, v191
    v_and_b32 v192, v188, v36
    v_and_b32 v193, v188, v37
    v_and_b32 v194, v189, v36
    v_and_b32 v195, v189, v37
    v_and_b32 v196, v190, v36
    v_and_b32 v197, v190, v37
    v_and_b32 v198, v191, v36
    v_and_b32 v199, v191, v37
    s_waitcnt vmcnt(12)
    v_mfma_f32_16x16x16_bf16 v[20:23], v[192:193], v[80:81], v[20:23]
    v_mfma_f32_16x16x16_bf16 v[24:27], v[192:193], v[82:83], v[24:27]
    v_mfma_f32_16x16x16_bf16 v[20:23], v[194:195], v[84:85], v[20:23]
    v_mfma_f32_16x16x16_bf16 v[24:27], v[194:195], v[86:87], v[24:27]
    v_mfma_f32_16x16x16_bf16 v[20:23], v[196:197], v[88:89], v[20:23]
    v_mfma_f32_16x16x16_bf16 v[24:27], v[196:197], v[90:91], v[24:27]
    v_mfma_f32_16x16x16_bf16 v[20:23], v[198:199], v[92:93], v[20:23]
    v_mfma_f32_16x16x16_bf16 v[24:27], v[198:199], v[94:95], v[24:27]
    buffer_load_dwordx4 v[80:83], v1, s[12:15], s45 offen offset:0 nt
    buffer_load_dwordx4 v[84:87], v1, s[12:15], s45 offen offset:1024 nt
    buffer_load_dwordx4 v[88:91], v1, s[12:15], s45 offen offset:2048 nt
    buffer_load_dwordx4 v[92:95], v1, s[12:15], s45 offen offset:3072 nt
    s_add_u32 s45, s45, 0x4000
    s_cmp_eq_u32 s45, s48
    s_cselect_b32 s10, 0, s10
    s_cselect_b32 s14, 0, s14
    s_sub_u32 s49, s49, 1
    s_cmp_eq_u32 s49, 0
    s_cbranch_scc1 A_FIN
A_TILE_1:
    s_waitcnt vmcnt(12)
    v_dot2_f32_bf16 v160, v96, v4, 0
    v_dot2_f32_bf16 v161, v96, v8, 0
    v_dot2_f32_bf16 v162, v96, v12, 0
    v_dot2_f32_bf16 v163, v96, v16, 0
    v_dot2_f32_bf16 v160, v97, v5, v160
    v_dot2_f32_bf16 v161, v97, v9, v161
    v_dot2_f32_bf16 v162, v97, v13, v162
    v_dot2_f32_bf16 v163, v97, v17, v163
    v_dot2_f32_bf16 v160, v98, v6, v160
    v_dot2_f32_bf16 v161, v98, v10, v161
    v_dot2_f32_bf16 v162, v98, v14, v162
    v_dot2_f32_bf16 v163, v98, v18, v163
    v_dot2_f32_bf16 v160, v99, v7, v160
    v_dot2_f32_bf16 v161, v99, v11, v161
    v_dot2_f32_bf16 v162, v99, v15, v162
    v_dot2_f32_bf16 v163, v99, v19, v163
    v_dot2_f32_bf16 v164, v100, v4, 0
    v_dot2_f32_bf16 v165, v100, v8, 0
    v_dot2_f32_bf16 v166, v100, v12, 0
    v_dot2_f32_bf16 v167, v100, v16, 0
    v_dot2_f32_bf16 v164, v101, v5, v164
    v_dot2_f32_bf16 v165, v101, v9, v165
    v_dot2_f32_bf16 v166, v101, v13, v166
    v_dot2_f32_bf16 v167, v101, v17, v167
    v_dot2_f32_bf16 v164, v102, v6, v164
    v_dot2_f32_bf16 v165, v102, v10, v165
    v_dot2_f32_bf16 v166, v102, v14, v166
    v_dot2_f32_bf16 v167, v102, v18, v167
    v_dot2_f32_bf16 v164, v103, v7, v164
    v_dot2_f32_bf16 v165, v103, v11, v165
    v_dot2_f32_bf16 v166, v103, v15, v166
    v_dot2_f32_bf16 v167, v103, v19, v167
    v_dot2_f32_bf16 v168, v104, v4, 0
    v_dot2_f32_bf16 v169, v104, v8, 0
    v_dot2_f32_bf16 v170, v104, v12, 0
    v_dot2_f32_bf16 v171, v104, v16, 0
    v_dot2_f32_bf16 v168, v105, v5, v168
    v_dot2_f32_bf16 v169, v105, v9, v169
    v_dot2_f32_bf16 v170, v105, v13, v170
    v_dot2_f32_bf16 v171, v105, v17, v171
    v_dot2_f32_bf16 v168, v106, v6, v168
    v_dot2_f32_bf16 v169, v106, v10, v169
    v_dot2_f32_bf16 v170, v106, v14, v170
    v_dot2_f32_bf16 v171, v106, v18, v171
    v_dot2_f32_bf16 v168, v107, v7, v168
    v_dot2_f32_bf16 v169, v107, v11, v169
    v_dot2_f32_bf16 v170, v107, v15, v170
    v_dot2_f32_bf16 v171, v107, v19, v171
    v_dot2_f32_bf16 v172, v108, v4, 0
    v_dot2_f32_bf16 v173, v108, v8, 0
    v_dot2_f32_bf16 v174, v108, v12, 0
    v_dot2_f32_bf16 v175, v108, v16, 0
    v_dot2_f32_bf16 v172, v109, v5, v172
    v_dot2_f32_bf16 v173, v109, v9, v173
    v_dot2_f32_bf16 v174, v109, v13, v174
    v_dot2_f32_bf16 v175, v109, v17, v175
    v_dot2_f32_bf16 v172, v110, v6, v172
    v_dot2_f32_bf16 v173, v110, v10, v173
    v_dot2_f32_bf16 v174, v110, v14, v174
    v_dot2_f32_bf16 v175, v110, v18, v175
    v_dot2_f32_bf16 v172, v111, v7, v172
    v_dot2_f32_bf16 v173, v111, v11, v173
    v_dot2_f32_bf16 v174, v111, v15, v174
    v_dot2_f32_bf16 v175, v111, v19, v175
    buffer_load_dwordx4 v[96:99], v1, s[8:11], s45 offen offset:0 nt
    buffer_load_dwordx4 v[100:103], v1, s[8:11], s45 offen offset:1024 nt
    buffer_load_dwordx4 v[104:107], v1, s[8:11], s45 offen offset:2048 nt
    buffer_load_dwordx4 v[108:111], v1, s[8:11], s45 offen offset:3072 nt
    v_add_f32_dpp v176, v160, v160 row_ror:8 row_mask:0xf bank_mask:0x3
    v_add_f32_dpp v178, v164, v164 row_ror:8 row_mask:0xf bank_mask:0x3
    v_add_f32_dpp v180, v168, v168 row_ror:8 row_mask:0xf bank_mask:0x3
    v_add_f32_dpp v182, v172, v172 row_ror:8 row_mask:0xf bank_mask:0x3
    v_add_f32_dpp v177, v161, v161 row_ror:8 row_mask:0xf bank_mask:0x3
    v_add_f32_dpp v179, v165, v165 row_ror:8 row_mask:0xf bank_mask:0x3
    v_add_f32_dpp v181, v169, v169 row_ror:8 row_mask:0xf bank_mask:0x3
    v_add_f32_dpp v183, v173, v173 row_ror:8 row_mask:0xf bank_mask:0x3
    v_add_f32_dpp v176, v162, v162 row_ror:8 row_mask:0xf bank_mask:0xc
    v_add_f32_dpp v178, v166, v166 row_ror:8 row_mask:0xf bank_mask:0xc
    v_add_f32_dpp v180, v170, v170 row_ror:8 row_mask:0xf bank_mask:0xc
    v_add_f32_dpp v182, v174, v174 row_ror:8 row_mask:0xf bank_mask:0xc
    v_add_f32_dpp v177, v163, v163 row_ror:8 row_mask:0xf bank_mask:0xc
    v_add_f32_dpp v179, v167, v167 row_ror:8 row_mask:0xf bank_mask:0xc
    v_add_f32_dpp v181, v171, v171 row_ror:8 row_mask:0xf bank_mask:0xc
    v_add_f32_dpp v183, v175, v175 row_ror:8 row_mask:0xf bank_mask:0xc
    v_add_f32_dpp v184, v176, v176 row_shl:4 row_mask:0xf bank_mask:0x5
    v_add_f32_dpp v185, v178, v178 row_shl:4 row_mask:0xf bank_mask:0x5
    v_add_f32_dpp v186, v180, v180 row_shl:4 row_mask:0xf bank_mask:0x5
    v_add_f32_dpp v187, v182, v182 row_shl:4 row_mask:0xf bank_mask:0x5
    v_add_f32_dpp v184, v177, v177 row_shr:4 row_mask:0xf bank_mask:0xa
    v_add_f32_dpp v185, v179, v179 row_shr:4 row_mask:0xf bank_mask:0xa
    v_add_f32_dpp v186, v181, v181 row_shr:4 row_mask:0xf bank_mask:0xa
    v_add_f32_dpp v187, v183, v183 row_shr:4 row_mask:0xf bank_mask:0xa
    v_add_f32_dpp v184, v184, v184 quad_perm:[2,3,0,1] row_mask:0xf bank_mask:0xf
    v_add_f32_dpp v185, v185, v185 quad_perm:[2,3,0,1] row_mask:0xf bank_mask:0xf
    v_add_f32_dpp v186, v186, v186 quad_perm:[2,3,0,1] row_mask:0xf bank_mask:0xf
    v_add_f32_dpp v187, v187, v187 quad_perm:[2,3,0,1] row_mask:0xf bank_mask:0xf
    v_add_f32_dpp v184, v184, v184 quad_perm:[1,0,3,2] row_mask:0xf bank_mask:0xf
    v_add_f32_dpp v185, v185, v185 quad_perm:[1,0,3,2] row_mask:0xf bank_mask:0xf
    v_add_f32_dpp v186, v186, v186 quad_perm:[1,0,3,2] row_mask:0xf bank_mask:0xf
    v_add_f32_dpp v187, v187, v187 quad_perm:[1,0,3,2] row_mask:0xf bank_mask:0xf
    v_cvt_pk_bf16_f32 v184, v184, v184
    v_cvt_pk_bf16_f32 v185, v185, v185
    v_cvt_pk_bf16_f32 v186, v186, v186
    v_cvt_pk_bf16_f32 v187, v187, v187
    v_and_b32 v184, s56, v184
    v_and_b32 v185, s56, v185
    v_and_b32 v186, s56, v186
    v_and_b32 v187, s56, v187
    v_mul_f32 v184, s55, v184
    v_mul_f32 v185, s55, v185
    v_mul_f32 v186, s55, v186
    v_mul_f32 v187, s55, v187
    v_cvt_pk_bf16_f32 v184, v184, v184
    v_cvt_pk_bf16_f32 v185, v185, v185
    v_cvt_pk_bf16_f32 v186, v186, v186
    v_cvt_pk_bf16_f32 v187, v187, v187
    v_and_b32 v184, s56, v184
    v_and_b32 v185, s56, v185
    v_and_b32 v186, s56, v186
    v_and_b32 v187, s56, v187
    v_fma_f32 v188, v184, s54, -v38
    v_fma_f32 v189, v185, s54, -v38
    v_fma_f32 v190, v186, s54, -v38
    v_fma_f32 v191, v187, s54, -v38
    v_max3_f32 v47, v188, v189, v190
    v_max_f32 v47, v47, v191
    v_cmp_lt_f32 vcc, 0, v47
    s_cbranch_vccnz A_SLOW_1
A_CONT_1:
    v_exp_f32 v188, v188
    v_exp_f32 v189, v189
    v_exp_f32 v190, v190
    v_exp_f32 v191, v191
    v_add_f32 v39, v39, v188
    v_add_f32 v47, v189, v190
    v_add_f32 v39, v39, v191
    v_add_f32 v39, v39, v47
    v_cvt_pk_bf16_f32 v188, v188, v188
    v_cvt_pk_bf16_f32 v189, v189, v189
    v_cvt_pk_bf16_f32 v190, v190, v190
    v_cvt_pk_bf16_f32 v191, v191, v191
    v_and_b32 v192, v188, v36
    v_and_b32 v193, v188, v37
    v_and_b32 v194, v189, v36
    v_and_b32 v195, v189, v37
    v_and_b32 v196, v190, v36
    v_and_b32 v197, v190, v37
    v_and_b32 v198, v191, v36
    v_and_b32 v199, v191, v37
    s_waitcnt vmcnt(12)
    v_mfma_f32_16x16x16_bf16 v[20:23], v[192:193], v[112:113], v[20:23]
    v_mfma_f32_16x16x16_bf16 v[24:27], v[192:193], v[114:115], v[24:27]
    v_mfma_f32_16x16x16_bf16 v[20:23], v[194:195], v[116:117], v[20:23]
    v_mfma_f32_16x16x16_bf16 v[24:27], v[194:195], v[118:119], v[24:27]
    v_mfma_f32_16x16x16_bf16 v[20:23], v[196:197], v[120:121], v[20:23]
    v_mfma_f32_16x16x16_bf16 v[24:27], v[196:197], v[122:123], v[24:27]
    v_mfma_f32_16x16x16_bf16 v[20:23], v[198:199], v[124:125], v[20:23]
    v_mfma_f32_16x16x16_bf16 v[24:27], v[198:199], v[126:127], v[24:27]
    buffer_load_dwordx4 v[112:115], v1, s[12:15], s45 offen offset:0 nt
    buffer_load_dwordx4 v[116:119], v1, s[12:15], s45 offen offset:1024 nt
    buffer_load_dwordx4 v[120:123], v1, s[12:15], s45 offen offset:2048 nt
    buffer_load_dwordx4 v[124:127], v1, s[12:15], s45 offen offset:3072 nt
    s_add_u32 s45, s45, 0x4000
    s_cmp_eq_u32 s45, s48
    s_cselect_b32 s10, 0, s10
    s_cselect_b32 s14, 0, s14
    s_sub_u32 s49, s49, 1
    s_cmp_eq_u32 s49, 0
    s_cbranch_scc1 A_FIN
    s_branch A_TILE_0
A_SLOW_0:
    v_max3_f32 v47, v184, v185, v186
    v_max_f32 v47, v47, v187
    v_mul_f32 v47, s54, v47
    v_mov_b32 v48, v47
    s_nop 1
    v_permlane16_swap_b32 v47, v48
    s_nop 1
    v_max_f32 v47, v47, v48
    v_mov_b32 v48, v47
    s_nop 1
    v_permlane32_swap_b32 v47, v48
    s_nop 1
    v_max_f32 v47, v47, v48
    v_max_f32 v47, v47, v38
    v_sub_f32 v48, v38, v47
    v_exp_f32 v48, v48
    v_mov_b32 v38, v47
    v_mul_f32 v39, v39, v48
    ds_bpermute_b32 v48, v59, v48
    v_fma_f32 v188, v184, s54, -v38
    v_fma_f32 v189, v185, s54, -v38
    v_fma_f32 v190, v186, s54, -v38
    v_fma_f32 v191, v187, s54, -v38
    s_waitcnt lgkmcnt(0)
    v_mul_f32 v20, v20, v48
    v_mul_f32 v21, v21, v48
    v_mul_f32 v22, v22, v48
    v_mul_f32 v23, v23, v48
    v_mul_f32 v24, v24, v48
    v_mul_f32 v25, v25, v48
    v_mul_f32 v26, v26, v48
    v_mul_f32 v27, v27, v48
    s_branch A_CONT_0
A_SLOW_1:
    v_max3_f32 v47, v184, v185, v186
    v_max_f32 v47, v47, v187
    v_mul_f32 v47, s54, v47
    v_mov_b32 v48, v47
    s_nop 1
    v_permlane16_swap_b32 v47, v48
    s_nop 1
    v_max_f32 v47, v47, v48
    v_mov_b32 v48, v47
    s_nop 1
    v_permlane32_swap_b32 v47, v48
    s_nop 1
    v_max_f32 v47, v47, v48
    v_max_f32 v47, v47, v38
    v_sub_f32 v48, v38, v47
    v_exp_f32 v48, v48
    v_mov_b32 v38, v47
    v_mul_f32 v39, v39, v48
    ds_bpermute_b32 v48, v59, v48
    v_fma_f32 v188, v184, s54, -v38
    v_fma_f32 v189, v185, s54, -v38
    v_fma_f32 v190, v186, s54, -v38
    v_fma_f32 v191, v187, s54, -v38
    s_waitcnt lgkmcnt(0)
    v_mul_f32 v20, v20, v48
    v_mul_f32 v21, v21, v48
    v_mul_f32 v22, v22, v48
    v_mul_f32 v23, v23, v48
    v_mul_f32 v24, v24, v48
    v_mul_f32 v25, v25, v48
    v_mul_f32 v26, v26, v48
    v_mul_f32 v27, v27, v48
    s_branch A_CONT_1
A_FIN:
    s_mov_b32 s58, 0x0
    buffer_load_dwordx4 a[0:3], v62, s[16:19], s58 offen offset:0
    buffer_load_dwordx4 a[4:7], v62, s[16:19], s58 offen offset:1024
    buffer_load_dwordx4 a[8:11], v62, s[16:19], s58 offen offset:2048
    buffer_load_dwordx4 a[12:15], v62, s[16:19], s58 offen offset:3072
    s_mov_b32 s58, 0x1000
    buffer_load_dwordx4 a[16:19], v62, s[16:19], s58 offen offset:0
    buffer_load_dwordx4 a[20:23], v62, s[16:19], s58 offen offset:1024
    buffer_load_dwordx4 a[24:27], v62, s[16:19], s58 offen offset:2048
    buffer_load_dwordx4 a[28:31], v62, s[16:19], s58 offen offset:3072
    s_mov_b32 s58, 0x2000
    buffer_load_dwordx4 a[32:35], v62, s[16:19], s58 offen offset:0
    buffer_load_dwordx4 a[36:39], v62, s[16:19], s58 offen offset:1024
    buffer_load_dwordx4 a[40:43], v62, s[16:19], s58 offen offset:2048
    buffer_load_dwordx4 a[44:47], v62, s[16:19], s58 offen offset:3072
    s_mov_b32 s58, 0x3000
    buffer_load_dwordx4 a[48:51], v62, s[16:19], s58 offen offset:0
    buffer_load_dwordx4 a[52:55], v62, s[16:19], s58 offen offset:1024
    buffer_load_dwordx4 a[56:59], v62, s[16:19], s58 offen offset:2048
    buffer_load_dwordx4 a[60:63], v62, s[16:19], s58 offen offset:3072
    s_mov_b32 s58, 0x4000
    buffer_load_dwordx4 a[64:67], v62, s[16:19], s58 offen offset:0
    buffer_load_dwordx4 a[68:71], v62, s[16:19], s58 offen offset:1024
    buffer_load_dwordx4 a[72:75], v62, s[16:19], s58 offen offset:2048
    buffer_load_dwordx4 a[76:79], v62, s[16:19], s58 offen offset:3072
    s_mov_b32 s58, 0x5000
    buffer_load_dwordx4 a[80:83], v62, s[16:19], s58 offen offset:0
    buffer_load_dwordx4 a[84:87], v62, s[16:19], s58 offen offset:1024
    buffer_load_dwordx4 a[88:91], v62, s[16:19], s58 offen offset:2048
    buffer_load_dwordx4 a[92:95], v62, s[16:19], s58 offen offset:3072
    s_mov_b32 s58, 0x6000
    buffer_load_dwordx4 a[96:99], v62, s[16:19], s58 offen offset:0
    buffer_load_dwordx4 a[100:103], v62, s[16:19], s58 offen offset:1024
    buffer_load_dwordx4 a[104:107], v62, s[16:19], s58 offen offset:2048
    buffer_load_dwordx4 a[108:111], v62, s[16:19], s58 offen offset:3072
    s_mov_b32 s58, 0x7000
    buffer_load_dwordx4 a[112:115], v62, s[16:19], s58 offen offset:0
    buffer_load_dwordx4 a[116:119], v62, s[16:19], s58 offen offset:1024
    buffer_load_dwordx4 a[120:123], v62, s[16:19], s58 offen offset:2048
    buffer_load_dwordx4 a[124:127], v62, s[16:19], s58 offen offset:3072
    s_waitcnt vmcnt(31)
    s_mov_b32 s58, 0x20000
    buffer_load_dwordx4 a[128:131], v62, s[16:19], s58 offen offset:0
    buffer_load_dwordx4 a[132:135], v62, s[16:19], s58 offen offset:1024
    buffer_load_dwordx4 a[136:139], v62, s[16:19], s58 offen offset:2048
    buffer_load_dwordx4 a[140:143], v62, s[16:19], s58 offen offset:3072
    s_mov_b32 s58, 0x21000
    buffer_load_dwordx4 a[144:147], v62, s[16:19], s58 offen offset:0
    buffer_load_dwordx4 a[148:151], v62, s[16:19], s58 offen offset:1024
    buffer_load_dwordx4 a[152:155], v62, s[16:19], s58 offen offset:2048
    buffer_load_dwordx4 a[156:159], v62, s[16:19], s58 offen offset:3072
    s_mov_b32 s58, 0x22000
    buffer_load_dwordx4 a[160:163], v62, s[16:19], s58 offen offset:0
    buffer_load_dwordx4 a[164:167], v62, s[16:19], s58 offen offset:1024
    buffer_load_dwordx4 a[168:171], v62, s[16:19], s58 offen offset:2048
    buffer_load_dwordx4 a[172:175], v62, s[16:19], s58 offen offset:3072
    s_mov_b32 s58, 0x23000
    buffer_load_dwordx4 a[176:179], v62, s[16:19], s58 offen offset:0
    buffer_load_dwordx4 a[180:183], v62, s[16:19], s58 offen offset:1024
    buffer_load_dwordx4 a[184:187], v62, s[16:19], s58 offen offset:2048
    buffer_load_dwordx4 a[188:191], v62, s[16:19], s58 offen offset:3072
    s_mov_b32 s58, 0x24000
    buffer_load_dwordx4 a[192:195], v62, s[16:19], s58 offen offset:0
    buffer_load_dwordx4 a[196:199], v62, s[16:19], s58 offen offset:1024
    buffer_load_dwordx4 a[200:203], v62, s[16:19], s58 offen offset:2048
    buffer_load_dwordx4 a[204:207], v62, s[16:19], s58 offen offset:3072
    s_mov_b32 s58, 0x25000
    buffer_load_dwordx4 a[208:211], v62, s[16:19], s58 offen offset:0
    buffer_load_dwordx4 a[212:215], v62, s[16:19], s58 offen offset:1024
    buffer_load_dwordx4 a[216:219], v62, s[16:19], s58 offen offset:2048
    buffer_load_dwordx4 a[220:223], v62, s[16:19], s58 offen offset:3072
    s_mov_b32 s58, 0x26000
    buffer_load_dwordx4 a[224:227], v62, s[16:19], s58 offen offset:0
    buffer_load_dwordx4 a[228:231], v62, s[16:19], s58 offen offset:1024
    buffer_load_dwordx4 a[232:235], v62, s[16:19], s58 offen offset:2048
    buffer_load_dwordx4 a[236:239], v62, s[16:19], s58 offen offset:3072
    s_mov_b32 s58, 0x27000
    buffer_load_dwordx4 a[240:243], v62, s[16:19], s58 offen offset:0
    buffer_load_dwordx4 a[244:247], v62, s[16:19], s58 offen offset:1024
    buffer_load_dwordx4 a[248:251], v62, s[16:19], s58 offen offset:2048
    buffer_load_dwordx4 a[252:255], v62, s[16:19], s58 offen offset:3072
    s_lshl_b32 s52, s3, 2
    v_add_u32 v47, s52, v3
    v_lshlrev_b32 v49, 2, v47
    v_lshlrev_b32 v47, 9, v47
    v_lshl_add_u32 v47, v58, 5, v47
    v_lshrrev_b32 v48, 2, v58
    v_lshl_add_u32 v49, v48, 6, v49
    v_lshl_add_u32 v48, v48, 4, s52
    ds_write_b128 v47, v[20:23] offset:4096
    ds_write_b128 v47, v[24:27] offset:4112
    ds_write_b32 v48, v38 offset:20480
    ds_write_b32 v49, v39 offset:20544
    v_lshrrev_b32 v47, 7, v0
    v_and_b32 v48, 127, v0
    v_lshlrev_b32 v49, 10, v47
    v_lshl_add_u32 v49, v48, 2, v49
    v_lshlrev_b32 v59, 5, v47
    v_lshlrev_b32 v60, 7, v47
    v_lshlrev_b32 v61, 9, v47
    v_lshl_add_u32 v61, v48, 1, v61
    s_waitcnt lgkmcnt(0)
    s_barrier
    ds_read_b128 v[192:195], v59 offset:20480
    ds_read2st64_b32 v[208:209], v49 offset0:16 offset1:24
    ds_read2st64_b32 v[210:211], v49 offset0:32 offset1:40
    ds_read_b128 v[4:7], v60 offset:20544
    ds_read_b128 v[8:11], v60 offset:20560
    ds_read_b128 v[12:15], v60 offset:20576
    ds_read_b128 v[16:19], v60 offset:20592
    s_waitcnt lgkmcnt(0)
    v_max3_f32 v196, v192, v193, v194
    v_max_f32 v196, v196, v195
    v_sub_f32 v192, v192, v196
    v_sub_f32 v193, v193, v196
    v_sub_f32 v194, v194, v196
    v_sub_f32 v195, v195, v196
    v_exp_f32 v192, v192
    v_exp_f32 v193, v193
    v_exp_f32 v194, v194
    v_exp_f32 v195, v195
    v_add_f32 v4, v4, v5
    v_add_f32 v6, v6, v7
    v_add_f32 v4, v4, v6
    v_add_f32 v8, v8, v9
    v_add_f32 v10, v10, v11
    v_add_f32 v8, v8, v10
    v_add_f32 v12, v12, v13
    v_add_f32 v14, v14, v15
    v_add_f32 v12, v12, v14
    v_add_f32 v16, v16, v17
    v_add_f32 v18, v18, v19
    v_add_f32 v16, v16, v18
    v_mul_f32 v197, v4, v192
    v_fmac_f32 v197, v8, v193
    v_fmac_f32 v197, v12, v194
    v_fmac_f32 v197, v16, v195
    v_mul_f32 v198, v208, v192
    v_rcp_f32 v199, v197
    v_fmac_f32 v198, v209, v193
    v_fmac_f32 v198, v210, v194
    v_fmac_f32 v198, v211, v195
    v_fma_f32 v200, -v197, v199, 1.0
    v_fmac_f32 v199, v200, v199
    v_mul_f32 v198, v198, v199
    v_cvt_pk_bf16_f32 v198, v198, v198
    s_nop 0
    ds_write_b16 v61, v198 offset:20992
    ds_read_b128 v[192:195], v59 offset:20496
    ds_read2st64_b32 v[208:209], v49 offset0:18 offset1:26
    ds_read2st64_b32 v[210:211], v49 offset0:34 offset1:42
    ds_read_b128 v[4:7], v60 offset:20608
    ds_read_b128 v[8:11], v60 offset:20624
    ds_read_b128 v[12:15], v60 offset:20640
    ds_read_b128 v[16:19], v60 offset:20656
    s_waitcnt lgkmcnt(0)
    v_max3_f32 v196, v192, v193, v194
    v_max_f32 v196, v196, v195
    v_sub_f32 v192, v192, v196
    v_sub_f32 v193, v193, v196
    v_sub_f32 v194, v194, v196
    v_sub_f32 v195, v195, v196
    v_exp_f32 v192, v192
    v_exp_f32 v193, v193
    v_exp_f32 v194, v194
    v_exp_f32 v195, v195
    v_add_f32 v4, v4, v5
    v_add_f32 v6, v6, v7
    v_add_f32 v4, v4, v6
    v_add_f32 v8, v8, v9
    v_add_f32 v10, v10, v11
    v_add_f32 v8, v8, v10
    v_add_f32 v12, v12, v13
    v_add_f32 v14, v14, v15
    v_add_f32 v12, v12, v14
    v_add_f32 v16, v16, v17
    v_add_f32 v18, v18, v19
    v_add_f32 v16, v16, v18
    v_mul_f32 v197, v4, v192
    v_fmac_f32 v197, v8, v193
    v_fmac_f32 v197, v12, v194
    v_fmac_f32 v197, v16, v195
    v_mul_f32 v198, v208, v192
    v_rcp_f32 v199, v197
    v_fmac_f32 v198, v209, v193
    v_fmac_f32 v198, v210, v194
    v_fmac_f32 v198, v211, v195
    v_fma_f32 v200, -v197, v199, 1.0
    v_fmac_f32 v199, v200, v199
    v_mul_f32 v198, v198, v199
    v_cvt_pk_bf16_f32 v198, v198, v198
    s_nop 0
    ds_write_b16 v61, v198 offset:21248
    v_lshlrev_b32 v59, 6, v3
    s_waitcnt lgkmcnt(0)
    s_barrier
    ds_read_b128 v[160:163], v59 offset:20992
    ds_read_b128 v[164:167], v59 offset:21008
    ds_read_b128 v[168:171], v59 offset:21024
    ds_read_b128 v[172:175], v59 offset:21040
    ds_read_b128 v[176:179], v59 offset:21248
    ds_read_b128 v[180:183], v59 offset:21264
    ds_read_b128 v[184:187], v59 offset:21280
    ds_read_b128 v[188:191], v59 offset:21296
    s_waitcnt lgkmcnt(0)
    ds_read_b128 v[192:195], v59 offset:21504
    ds_read_b128 v[196:199], v59 offset:21520
    ds_read_b128 v[200:203], v59 offset:21536
    ds_read_b128 v[204:207], v59 offset:21552
    ds_read_b128 v[208:211], v59 offset:21760
    ds_read_b128 v[212:215], v59 offset:21776
    ds_read_b128 v[216:219], v59 offset:21792
    ds_read_b128 v[220:223], v59 offset:21808
    v_mov_b32 v28, 0
    v_mov_b32 v29, 0
    v_mov_b32 v30, 0
    v_mov_b32 v31, 0
    s_waitcnt vmcnt(32) lgkmcnt(0)
    v_perm_b32 v224, v160, v160, v240
    v_perm_b32 v225, v160, v160, v241
    v_perm_b32 v226, v160, v160, v242
    v_perm_b32 v227, v160, v160, v243
    v_perm_b32 v228, v160, v160, v244
    v_perm_b32 v229, v160, v160, v245
    v_perm_b32 v230, v160, v160, v246
    v_perm_b32 v231, v160, v160, v247
    v_mfma_f32_16x16x32_bf16 v[28:31], v[224:227], a[0:3], v[28:31]
    v_perm_b32 v232, v161, v161, v240
    v_perm_b32 v233, v161, v161, v241
    v_perm_b32 v234, v161, v161, v242
    v_perm_b32 v235, v161, v161, v243
    v_mfma_f32_16x16x32_bf16 v[28:31], v[228:231], a[4:7], v[28:31]
    v_perm_b32 v236, v161, v161, v244
    v_perm_b32 v237, v161, v161, v245
    v_perm_b32 v238, v161, v161, v246
    v_perm_b32 v239, v161, v161, v247
    v_mfma_f32_16x16x32_bf16 v[28:31], v[232:235], a[8:11], v[28:31]
    v_perm_b32 v224, v162, v162, v240
    v_perm_b32 v225, v162, v162, v241
    v_perm_b32 v226, v162, v162, v242
    v_perm_b32 v227, v162, v162, v243
    v_mfma_f32_16x16x32_bf16 v[28:31], v[236:239], a[12:15], v[28:31]
    v_perm_b32 v228, v162, v162, v244
    v_perm_b32 v229, v162, v162, v245
    v_perm_b32 v230, v162, v162, v246
    v_perm_b32 v231, v162, v162, v247
    v_mfma_f32_16x16x32_bf16 v[28:31], v[224:227], a[16:19], v[28:31]
    v_perm_b32 v232, v163, v163, v240
    v_perm_b32 v233, v163, v163, v241
    v_perm_b32 v234, v163, v163, v242
    v_perm_b32 v235, v163, v163, v243
    v_mfma_f32_16x16x32_bf16 v[28:31], v[228:231], a[20:23], v[28:31]
    v_perm_b32 v236, v163, v163, v244
    v_perm_b32 v237, v163, v163, v245
    v_perm_b32 v238, v163, v163, v246
    v_perm_b32 v239, v163, v163, v247
    v_mfma_f32_16x16x32_bf16 v[28:31], v[232:235], a[24:27], v[28:31]
    v_perm_b32 v224, v164, v164, v240
    v_perm_b32 v225, v164, v164, v241
    v_perm_b32 v226, v164, v164, v242
    v_perm_b32 v227, v164, v164, v243
    v_mfma_f32_16x16x32_bf16 v[28:31], v[236:239], a[28:31], v[28:31]
    v_perm_b32 v228, v164, v164, v244
    v_perm_b32 v229, v164, v164, v245
    v_perm_b32 v230, v164, v164, v246
    v_perm_b32 v231, v164, v164, v247
    v_mfma_f32_16x16x32_bf16 v[28:31], v[224:227], a[32:35], v[28:31]
    v_perm_b32 v232, v165, v165, v240
    v_perm_b32 v233, v165, v165, v241
    v_perm_b32 v234, v165, v165, v242
    v_perm_b32 v235, v165, v165, v243
    v_mfma_f32_16x16x32_bf16 v[28:31], v[228:231], a[36:39], v[28:31]
    v_perm_b32 v236, v165, v165, v244
    v_perm_b32 v237, v165, v165, v245
    v_perm_b32 v238, v165, v165, v246
    v_perm_b32 v239, v165, v165, v247
    v_mfma_f32_16x16x32_bf16 v[28:31], v[232:235], a[40:43], v[28:31]
    v_perm_b32 v224, v166, v166, v240
    v_perm_b32 v225, v166, v166, v241
    v_perm_b32 v226, v166, v166, v242
    v_perm_b32 v227, v166, v166, v243
    v_mfma_f32_16x16x32_bf16 v[28:31], v[236:239], a[44:47], v[28:31]
    v_perm_b32 v228, v166, v166, v244
    v_perm_b32 v229, v166, v166, v245
    v_perm_b32 v230, v166, v166, v246
    v_perm_b32 v231, v166, v166, v247
    v_mfma_f32_16x16x32_bf16 v[28:31], v[224:227], a[48:51], v[28:31]
    v_perm_b32 v232, v167, v167, v240
    v_perm_b32 v233, v167, v167, v241
    v_perm_b32 v234, v167, v167, v242
    v_perm_b32 v235, v167, v167, v243
    v_mfma_f32_16x16x32_bf16 v[28:31], v[228:231], a[52:55], v[28:31]
    v_perm_b32 v236, v167, v167, v244
    v_perm_b32 v237, v167, v167, v245
    v_perm_b32 v238, v167, v167, v246
    v_perm_b32 v239, v167, v167, v247
    v_mfma_f32_16x16x32_bf16 v[28:31], v[232:235], a[56:59], v[28:31]
    v_perm_b32 v224, v168, v168, v240
    v_perm_b32 v225, v168, v168, v241
    v_perm_b32 v226, v168, v168, v242
    v_perm_b32 v227, v168, v168, v243
    v_mfma_f32_16x16x32_bf16 v[28:31], v[236:239], a[60:63], v[28:31]
    v_perm_b32 v228, v168, v168, v244
    v_perm_b32 v229, v168, v168, v245
    v_perm_b32 v230, v168, v168, v246
    v_perm_b32 v231, v168, v168, v247
    v_mfma_f32_16x16x32_bf16 v[28:31], v[224:227], a[64:67], v[28:31]
    v_perm_b32 v232, v169, v169, v240
    v_perm_b32 v233, v169, v169, v241
    v_perm_b32 v234, v169, v169, v242
    v_perm_b32 v235, v169, v169, v243
    v_mfma_f32_16x16x32_bf16 v[28:31], v[228:231], a[68:71], v[28:31]
    v_perm_b32 v236, v169, v169, v244
    v_perm_b32 v237, v169, v169, v245
    v_perm_b32 v238, v169, v169, v246
    v_perm_b32 v239, v169, v169, v247
    v_mfma_f32_16x16x32_bf16 v[28:31], v[232:235], a[72:75], v[28:31]
    v_perm_b32 v224, v170, v170, v240
    v_perm_b32 v225, v170, v170, v241
    v_perm_b32 v226, v170, v170, v242
    v_perm_b32 v227, v170, v170, v243
    v_mfma_f32_16x16x32_bf16 v[28:31], v[236:239], a[76:79], v[28:31]
    v_perm_b32 v228, v170, v170, v244
    v_perm_b32 v229, v170, v170, v245
    v_perm_b32 v230, v170, v170, v246
    v_perm_b32 v231, v170, v170, v247
    v_mfma_f32_16x16x32_bf16 v[28:31], v[224:227], a[80:83], v[28:31]
    v_perm_b32 v232, v171, v171, v240
    v_perm_b32 v233, v171, v171, v241
    v_perm_b32 v234, v171, v171, v242
    v_perm_b32 v235, v171, v171, v243
    v_mfma_f32_16x16x32_bf16 v[28:31], v[228:231], a[84:87], v[28:31]
    v_perm_b32 v236, v171, v171, v244
    v_perm_b32 v237, v171, v171, v245
    v_perm_b32 v238, v171, v171, v246
    v_perm_b32 v239, v171, v171, v247
    v_mfma_f32_16x16x32_bf16 v[28:31], v[232:235], a[88:91], v[28:31]
    v_perm_b32 v224, v172, v172, v240
    v_perm_b32 v225, v172, v172, v241
    v_perm_b32 v226, v172, v172, v242
    v_perm_b32 v227, v172, v172, v243
    v_mfma_f32_16x16x32_bf16 v[28:31], v[236:239], a[92:95], v[28:31]
    v_perm_b32 v228, v172, v172, v244
    v_perm_b32 v229, v172, v172, v245
    v_perm_b32 v230, v172, v172, v246
    v_perm_b32 v231, v172, v172, v247
    v_mfma_f32_16x16x32_bf16 v[28:31], v[224:227], a[96:99], v[28:31]
    v_perm_b32 v232, v173, v173, v240
    v_perm_b32 v233, v173, v173, v241
    v_perm_b32 v234, v173, v173, v242
    v_perm_b32 v235, v173, v173, v243
    v_mfma_f32_16x16x32_bf16 v[28:31], v[228:231], a[100:103], v[28:31]
    v_perm_b32 v236, v173, v173, v244
    v_perm_b32 v237, v173, v173, v245
    v_perm_b32 v238, v173, v173, v246
    v_perm_b32 v239, v173, v173, v247
    v_mfma_f32_16x16x32_bf16 v[28:31], v[232:235], a[104:107], v[28:31]
    v_perm_b32 v224, v174, v174, v240
    v_perm_b32 v225, v174, v174, v241
    v_perm_b32 v226, v174, v174, v242
    v_perm_b32 v227, v174, v174, v243
    v_mfma_f32_16x16x32_bf16 v[28:31], v[236:239], a[108:111], v[28:31]
    v_perm_b32 v228, v174, v174, v244
    v_perm_b32 v229, v174, v174, v245
    v_perm_b32 v230, v174, v174, v246
    v_perm_b32 v231, v174, v174, v247
    v_mfma_f32_16x16x32_bf16 v[28:31], v[224:227], a[112:115], v[28:31]
    v_perm_b32 v232, v175, v175, v240
    v_perm_b32 v233, v175, v175, v241
    v_perm_b32 v234, v175, v175, v242
    v_perm_b32 v235, v175, v175, v243
    v_mfma_f32_16x16x32_bf16 v[28:31], v[228:231], a[116:119], v[28:31]
    v_perm_b32 v236, v175, v175, v244
    v_perm_b32 v237, v175, v175, v245
    v_perm_b32 v238, v175, v175, v246
    v_perm_b32 v239, v175, v175, v247
    v_mfma_f32_16x16x32_bf16 v[28:31], v[232:235], a[120:123], v[28:31]
    s_nop 1
    v_mfma_f32_16x16x32_bf16 v[28:31], v[236:239], a[124:127], v[28:31]
    s_waitcnt vmcnt(31)
    s_mov_b32 s58, 0x40000
    buffer_load_dwordx4 a[0:3], v62, s[16:19], s58 offen offset:0
    buffer_load_dwordx4 a[4:7], v62, s[16:19], s58 offen offset:1024
    buffer_load_dwordx4 a[8:11], v62, s[16:19], s58 offen offset:2048
    buffer_load_dwordx4 a[12:15], v62, s[16:19], s58 offen offset:3072
    s_mov_b32 s58, 0x41000
    buffer_load_dwordx4 a[16:19], v62, s[16:19], s58 offen offset:0
    buffer_load_dwordx4 a[20:23], v62, s[16:19], s58 offen offset:1024
    buffer_load_dwordx4 a[24:27], v62, s[16:19], s58 offen offset:2048
    buffer_load_dwordx4 a[28:31], v62, s[16:19], s58 offen offset:3072
    s_mov_b32 s58, 0x42000
    buffer_load_dwordx4 a[32:35], v62, s[16:19], s58 offen offset:0
    buffer_load_dwordx4 a[36:39], v62, s[16:19], s58 offen offset:1024
    buffer_load_dwordx4 a[40:43], v62, s[16:19], s58 offen offset:2048
    buffer_load_dwordx4 a[44:47], v62, s[16:19], s58 offen offset:3072
    s_mov_b32 s58, 0x43000
    buffer_load_dwordx4 a[48:51], v62, s[16:19], s58 offen offset:0
    buffer_load_dwordx4 a[52:55], v62, s[16:19], s58 offen offset:1024
    buffer_load_dwordx4 a[56:59], v62, s[16:19], s58 offen offset:2048
    buffer_load_dwordx4 a[60:63], v62, s[16:19], s58 offen offset:3072
    s_mov_b32 s58, 0x44000
    buffer_load_dwordx4 a[64:67], v62, s[16:19], s58 offen offset:0
    buffer_load_dwordx4 a[68:71], v62, s[16:19], s58 offen offset:1024
    buffer_load_dwordx4 a[72:75], v62, s[16:19], s58 offen offset:2048
    buffer_load_dwordx4 a[76:79], v62, s[16:19], s58 offen offset:3072
    s_mov_b32 s58, 0x45000
    buffer_load_dwordx4 a[80:83], v62, s[16:19], s58 offen offset:0
    buffer_load_dwordx4 a[84:87], v62, s[16:19], s58 offen offset:1024
    buffer_load_dwordx4 a[88:91], v62, s[16:19], s58 offen offset:2048
    buffer_load_dwordx4 a[92:95], v62, s[16:19], s58 offen offset:3072
    s_mov_b32 s58, 0x46000
    buffer_load_dwordx4 a[96:99], v62, s[16:19], s58 offen offset:0
    buffer_load_dwordx4 a[100:103], v62, s[16:19], s58 offen offset:1024
    buffer_load_dwordx4 a[104:107], v62, s[16:19], s58 offen offset:2048
    buffer_load_dwordx4 a[108:111], v62, s[16:19], s58 offen offset:3072
    s_mov_b32 s58, 0x47000
    buffer_load_dwordx4 a[112:115], v62, s[16:19], s58 offen offset:0
    buffer_load_dwordx4 a[116:119], v62, s[16:19], s58 offen offset:1024
    buffer_load_dwordx4 a[120:123], v62, s[16:19], s58 offen offset:2048
    buffer_load_dwordx4 a[124:127], v62, s[16:19], s58 offen offset:3072
    s_waitcnt vmcnt(32)
    v_perm_b32 v224, v176, v176, v240
    v_perm_b32 v225, v176, v176, v241
    v_perm_b32 v226, v176, v176, v242
    v_perm_b32 v227, v176, v176, v243
    v_perm_b32 v228, v176, v176, v244
    v_perm_b32 v229, v176, v176, v245
    v_perm_b32 v230, v176, v176, v246
    v_perm_b32 v231, v176, v176, v247
    v_mfma_f32_16x16x32_bf16 v[28:31], v[224:227], a[128:131], v[28:31]
    v_perm_b32 v232, v177, v177, v240
    v_perm_b32 v233, v177, v177, v241
    v_perm_b32 v234, v177, v177, v242
    v_perm_b32 v235, v177, v177, v243
    v_mfma_f32_16x16x32_bf16 v[28:31], v[228:231], a[132:135], v[28:31]
    v_perm_b32 v236, v177, v177, v244
    v_perm_b32 v237, v177, v177, v245
    v_perm_b32 v238, v177, v177, v246
    v_perm_b32 v239, v177, v177, v247
    v_mfma_f32_16x16x32_bf16 v[28:31], v[232:235], a[136:139], v[28:31]
    v_perm_b32 v224, v178, v178, v240
    v_perm_b32 v225, v178, v178, v241
    v_perm_b32 v226, v178, v178, v242
    v_perm_b32 v227, v178, v178, v243
    v_mfma_f32_16x16x32_bf16 v[28:31], v[236:239], a[140:143], v[28:31]
    v_perm_b32 v228, v178, v178, v244
    v_perm_b32 v229, v178, v178, v245
    v_perm_b32 v230, v178, v178, v246
    v_perm_b32 v231, v178, v178, v247
    v_mfma_f32_16x16x32_bf16 v[28:31], v[224:227], a[144:147], v[28:31]
    v_perm_b32 v232, v179, v179, v240
    v_perm_b32 v233, v179, v179, v241
    v_perm_b32 v234, v179, v179, v242
    v_perm_b32 v235, v179, v179, v243
    v_mfma_f32_16x16x32_bf16 v[28:31], v[228:231], a[148:151], v[28:31]
    v_perm_b32 v236, v179, v179, v244
    v_perm_b32 v237, v179, v179, v245
    v_perm_b32 v238, v179, v179, v246
    v_perm_b32 v239, v179, v179, v247
    v_mfma_f32_16x16x32_bf16 v[28:31], v[232:235], a[152:155], v[28:31]
    v_perm_b32 v224, v180, v180, v240
    v_perm_b32 v225, v180, v180, v241
    v_perm_b32 v226, v180, v180, v242
    v_perm_b32 v227, v180, v180, v243
    v_mfma_f32_16x16x32_bf16 v[28:31], v[236:239], a[156:159], v[28:31]
    v_perm_b32 v228, v180, v180, v244
    v_perm_b32 v229, v180, v180, v245
    v_perm_b32 v230, v180, v180, v246
    v_perm_b32 v231, v180, v180, v247
    v_mfma_f32_16x16x32_bf16 v[28:31], v[224:227], a[160:163], v[28:31]
    v_perm_b32 v232, v181, v181, v240
    v_perm_b32 v233, v181, v181, v241
    v_perm_b32 v234, v181, v181, v242
    v_perm_b32 v235, v181, v181, v243
    v_mfma_f32_16x16x32_bf16 v[28:31], v[228:231], a[164:167], v[28:31]
    v_perm_b32 v236, v181, v181, v244
    v_perm_b32 v237, v181, v181, v245
    v_perm_b32 v238, v181, v181, v246
    v_perm_b32 v239, v181, v181, v247
    v_mfma_f32_16x16x32_bf16 v[28:31], v[232:235], a[168:171], v[28:31]
    v_perm_b32 v224, v182, v182, v240
    v_perm_b32 v225, v182, v182, v241
    v_perm_b32 v226, v182, v182, v242
    v_perm_b32 v227, v182, v182, v243
    v_mfma_f32_16x16x32_bf16 v[28:31], v[236:239], a[172:175], v[28:31]
    v_perm_b32 v228, v182, v182, v244
    v_perm_b32 v229, v182, v182, v245
    v_perm_b32 v230, v182, v182, v246
    v_perm_b32 v231, v182, v182, v247
    v_mfma_f32_16x16x32_bf16 v[28:31], v[224:227], a[176:179], v[28:31]
    v_perm_b32 v232, v183, v183, v240
    v_perm_b32 v233, v183, v183, v241
    v_perm_b32 v234, v183, v183, v242
    v_perm_b32 v235, v183, v183, v243
    v_mfma_f32_16x16x32_bf16 v[28:31], v[228:231], a[180:183], v[28:31]
    v_perm_b32 v236, v183, v183, v244
    v_perm_b32 v237, v183, v183, v245
    v_perm_b32 v238, v183, v183, v246
    v_perm_b32 v239, v183, v183, v247
    v_mfma_f32_16x16x32_bf16 v[28:31], v[232:235], a[184:187], v[28:31]
    v_perm_b32 v224, v184, v184, v240
    v_perm_b32 v225, v184, v184, v241
    v_perm_b32 v226, v184, v184, v242
    v_perm_b32 v227, v184, v184, v243
    v_mfma_f32_16x16x32_bf16 v[28:31], v[236:239], a[188:191], v[28:31]
    v_perm_b32 v228, v184, v184, v244
    v_perm_b32 v229, v184, v184, v245
    v_perm_b32 v230, v184, v184, v246
    v_perm_b32 v231, v184, v184, v247
    v_mfma_f32_16x16x32_bf16 v[28:31], v[224:227], a[192:195], v[28:31]
    v_perm_b32 v232, v185, v185, v240
    v_perm_b32 v233, v185, v185, v241
    v_perm_b32 v234, v185, v185, v242
    v_perm_b32 v235, v185, v185, v243
    v_mfma_f32_16x16x32_bf16 v[28:31], v[228:231], a[196:199], v[28:31]
    v_perm_b32 v236, v185, v185, v244
    v_perm_b32 v237, v185, v185, v245
    v_perm_b32 v238, v185, v185, v246
    v_perm_b32 v239, v185, v185, v247
    v_mfma_f32_16x16x32_bf16 v[28:31], v[232:235], a[200:203], v[28:31]
    v_perm_b32 v224, v186, v186, v240
    v_perm_b32 v225, v186, v186, v241
    v_perm_b32 v226, v186, v186, v242
    v_perm_b32 v227, v186, v186, v243
    v_mfma_f32_16x16x32_bf16 v[28:31], v[236:239], a[204:207], v[28:31]
    v_perm_b32 v228, v186, v186, v244
    v_perm_b32 v229, v186, v186, v245
    v_perm_b32 v230, v186, v186, v246
    v_perm_b32 v231, v186, v186, v247
    v_mfma_f32_16x16x32_bf16 v[28:31], v[224:227], a[208:211], v[28:31]
    v_perm_b32 v232, v187, v187, v240
    v_perm_b32 v233, v187, v187, v241
    v_perm_b32 v234, v187, v187, v242
    v_perm_b32 v235, v187, v187, v243
    v_mfma_f32_16x16x32_bf16 v[28:31], v[228:231], a[212:215], v[28:31]
    v_perm_b32 v236, v187, v187, v244
    v_perm_b32 v237, v187, v187, v245
    v_perm_b32 v238, v187, v187, v246
    v_perm_b32 v239, v187, v187, v247
    v_mfma_f32_16x16x32_bf16 v[28:31], v[232:235], a[216:219], v[28:31]
    v_perm_b32 v224, v188, v188, v240
    v_perm_b32 v225, v188, v188, v241
    v_perm_b32 v226, v188, v188, v242
    v_perm_b32 v227, v188, v188, v243
    v_mfma_f32_16x16x32_bf16 v[28:31], v[236:239], a[220:223], v[28:31]
    v_perm_b32 v228, v188, v188, v244
    v_perm_b32 v229, v188, v188, v245
    v_perm_b32 v230, v188, v188, v246
    v_perm_b32 v231, v188, v188, v247
    v_mfma_f32_16x16x32_bf16 v[28:31], v[224:227], a[224:227], v[28:31]
    v_perm_b32 v232, v189, v189, v240
    v_perm_b32 v233, v189, v189, v241
    v_perm_b32 v234, v189, v189, v242
    v_perm_b32 v235, v189, v189, v243
    v_mfma_f32_16x16x32_bf16 v[28:31], v[228:231], a[228:231], v[28:31]
    v_perm_b32 v236, v189, v189, v244
    v_perm_b32 v237, v189, v189, v245
    v_perm_b32 v238, v189, v189, v246
    v_perm_b32 v239, v189, v189, v247
    v_mfma_f32_16x16x32_bf16 v[28:31], v[232:235], a[232:235], v[28:31]
    v_perm_b32 v224, v190, v190, v240
    v_perm_b32 v225, v190, v190, v241
    v_perm_b32 v226, v190, v190, v242
    v_perm_b32 v227, v190, v190, v243
    v_mfma_f32_16x16x32_bf16 v[28:31], v[236:239], a[236:239], v[28:31]
    v_perm_b32 v228, v190, v190, v244
    v_perm_b32 v229, v190, v190, v245
    v_perm_b32 v230, v190, v190, v246
    v_perm_b32 v231, v190, v190, v247
    v_mfma_f32_16x16x32_bf16 v[28:31], v[224:227], a[240:243], v[28:31]
    v_perm_b32 v232, v191, v191, v240
    v_perm_b32 v233, v191, v191, v241
    v_perm_b32 v234, v191, v191, v242
    v_perm_b32 v235, v191, v191, v243
    v_mfma_f32_16x16x32_bf16 v[28:31], v[228:231], a[244:247], v[28:31]
    v_perm_b32 v236, v191, v191, v244
    v_perm_b32 v237, v191, v191, v245
    v_perm_b32 v238, v191, v191, v246
    v_perm_b32 v239, v191, v191, v247
    v_mfma_f32_16x16x32_bf16 v[28:31], v[232:235], a[248:251], v[28:31]
    s_nop 1
    v_mfma_f32_16x16x32_bf16 v[28:31], v[236:239], a[252:255], v[28:31]
    s_waitcnt vmcnt(31)
    s_mov_b32 s58, 0x60000
    buffer_load_dwordx4 a[128:131], v62, s[16:19], s58 offen offset:0
    buffer_load_dwordx4 a[132:135], v62, s[16:19], s58 offen offset:1024
    buffer_load_dwordx4 a[136:139], v62, s[16:19], s58 offen offset:2048
    buffer_load_dwordx4 a[140:143], v62, s[16:19], s58 offen offset:3072
    s_mov_b32 s58, 0x61000
    buffer_load_dwordx4 a[144:147], v62, s[16:19], s58 offen offset:0
    buffer_load_dwordx4 a[148:151], v62, s[16:19], s58 offen offset:1024
    buffer_load_dwordx4 a[152:155], v62, s[16:19], s58 offen offset:2048
    buffer_load_dwordx4 a[156:159], v62, s[16:19], s58 offen offset:3072
    s_mov_b32 s58, 0x62000
    buffer_load_dwordx4 a[160:163], v62, s[16:19], s58 offen offset:0
    buffer_load_dwordx4 a[164:167], v62, s[16:19], s58 offen offset:1024
    buffer_load_dwordx4 a[168:171], v62, s[16:19], s58 offen offset:2048
    buffer_load_dwordx4 a[172:175], v62, s[16:19], s58 offen offset:3072
    s_mov_b32 s58, 0x63000
    buffer_load_dwordx4 a[176:179], v62, s[16:19], s58 offen offset:0
    buffer_load_dwordx4 a[180:183], v62, s[16:19], s58 offen offset:1024
    buffer_load_dwordx4 a[184:187], v62, s[16:19], s58 offen offset:2048
    buffer_load_dwordx4 a[188:191], v62, s[16:19], s58 offen offset:3072
    s_mov_b32 s58, 0x64000
    buffer_load_dwordx4 a[192:195], v62, s[16:19], s58 offen offset:0
    buffer_load_dwordx4 a[196:199], v62, s[16:19], s58 offen offset:1024
    buffer_load_dwordx4 a[200:203], v62, s[16:19], s58 offen offset:2048
    buffer_load_dwordx4 a[204:207], v62, s[16:19], s58 offen offset:3072
    s_mov_b32 s58, 0x65000
    buffer_load_dwordx4 a[208:211], v62, s[16:19], s58 offen offset:0
    buffer_load_dwordx4 a[212:215], v62, s[16:19], s58 offen offset:1024
    buffer_load_dwordx4 a[216:219], v62, s[16:19], s58 offen offset:2048
    buffer_load_dwordx4 a[220:223], v62, s[16:19], s58 offen offset:3072
    s_mov_b32 s58, 0x66000
    buffer_load_dwordx4 a[224:227], v62, s[16:19], s58 offen offset:0
    buffer_load_dwordx4 a[228:231], v62, s[16:19], s58 offen offset:1024
    buffer_load_dwordx4 a[232:235], v62, s[16:19], s58 offen offset:2048
    buffer_load_dwordx4 a[236:239], v62, s[16:19], s58 offen offset:3072
    s_mov_b32 s58, 0x67000
    buffer_load_dwordx4 a[240:243], v62, s[16:19], s58 offen offset:0
    buffer_load_dwordx4 a[244:247], v62, s[16:19], s58 offen offset:1024
    buffer_load_dwordx4 a[248:251], v62, s[16:19], s58 offen offset:2048
    buffer_load_dwordx4 a[252:255], v62, s[16:19], s58 offen offset:3072
    s_waitcnt vmcnt(32)
    v_perm_b32 v224, v192, v192, v240
    v_perm_b32 v225, v192, v192, v241
    v_perm_b32 v226, v192, v192, v242
    v_perm_b32 v227, v192, v192, v243
    v_perm_b32 v228, v192, v192, v244
    v_perm_b32 v229, v192, v192, v245
    v_perm_b32 v230, v192, v192, v246
    v_perm_b32 v231, v192, v192, v247
    v_mfma_f32_16x16x32_bf16 v[28:31], v[224:227], a[0:3], v[28:31]
    v_perm_b32 v232, v193, v193, v240
    v_perm_b32 v233, v193, v193, v241
    v_perm_b32 v234, v193, v193, v242
    v_perm_b32 v235, v193, v193, v243
    v_mfma_f32_16x16x32_bf16 v[28:31], v[228:231], a[4:7], v[28:31]
    v_perm_b32 v236, v193, v193, v244
    v_perm_b32 v237, v193, v193, v245
    v_perm_b32 v238, v193, v193, v246
    v_perm_b32 v239, v193, v193, v247
    v_mfma_f32_16x16x32_bf16 v[28:31], v[232:235], a[8:11], v[28:31]
    v_perm_b32 v224, v194, v194, v240
    v_perm_b32 v225, v194, v194, v241
    v_perm_b32 v226, v194, v194, v242
    v_perm_b32 v227, v194, v194, v243
    v_mfma_f32_16x16x32_bf16 v[28:31], v[236:239], a[12:15], v[28:31]
    v_perm_b32 v228, v194, v194, v244
    v_perm_b32 v229, v194, v194, v245
    v_perm_b32 v230, v194, v194, v246
    v_perm_b32 v231, v194, v194, v247
    v_mfma_f32_16x16x32_bf16 v[28:31], v[224:227], a[16:19], v[28:31]
    v_perm_b32 v232, v195, v195, v240
    v_perm_b32 v233, v195, v195, v241
    v_perm_b32 v234, v195, v195, v242
    v_perm_b32 v235, v195, v195, v243
    v_mfma_f32_16x16x32_bf16 v[28:31], v[228:231], a[20:23], v[28:31]
    v_perm_b32 v236, v195, v195, v244
    v_perm_b32 v237, v195, v195, v245
    v_perm_b32 v238, v195, v195, v246
    v_perm_b32 v239, v195, v195, v247
    v_mfma_f32_16x16x32_bf16 v[28:31], v[232:235], a[24:27], v[28:31]
    v_perm_b32 v224, v196, v196, v240
    v_perm_b32 v225, v196, v196, v241
    v_perm_b32 v226, v196, v196, v242
    v_perm_b32 v227, v196, v196, v243
    v_mfma_f32_16x16x32_bf16 v[28:31], v[236:239], a[28:31], v[28:31]
    v_perm_b32 v228, v196, v196, v244
    v_perm_b32 v229, v196, v196, v245
    v_perm_b32 v230, v196, v196, v246
    v_perm_b32 v231, v196, v196, v247
    v_mfma_f32_16x16x32_bf16 v[28:31], v[224:227], a[32:35], v[28:31]
    v_perm_b32 v232, v197, v197, v240
    v_perm_b32 v233, v197, v197, v241
    v_perm_b32 v234, v197, v197, v242
    v_perm_b32 v235, v197, v197, v243
    v_mfma_f32_16x16x32_bf16 v[28:31], v[228:231], a[36:39], v[28:31]
    v_perm_b32 v236, v197, v197, v244
    v_perm_b32 v237, v197, v197, v245
    v_perm_b32 v238, v197, v197, v246
    v_perm_b32 v239, v197, v197, v247
    v_mfma_f32_16x16x32_bf16 v[28:31], v[232:235], a[40:43], v[28:31]
    v_perm_b32 v224, v198, v198, v240
    v_perm_b32 v225, v198, v198, v241
    v_perm_b32 v226, v198, v198, v242
    v_perm_b32 v227, v198, v198, v243
    v_mfma_f32_16x16x32_bf16 v[28:31], v[236:239], a[44:47], v[28:31]
    v_perm_b32 v228, v198, v198, v244
    v_perm_b32 v229, v198, v198, v245
    v_perm_b32 v230, v198, v198, v246
    v_perm_b32 v231, v198, v198, v247
    v_mfma_f32_16x16x32_bf16 v[28:31], v[224:227], a[48:51], v[28:31]
    v_perm_b32 v232, v199, v199, v240
    v_perm_b32 v233, v199, v199, v241
    v_perm_b32 v234, v199, v199, v242
    v_perm_b32 v235, v199, v199, v243
    v_mfma_f32_16x16x32_bf16 v[28:31], v[228:231], a[52:55], v[28:31]
    v_perm_b32 v236, v199, v199, v244
    v_perm_b32 v237, v199, v199, v245
    v_perm_b32 v238, v199, v199, v246
    v_perm_b32 v239, v199, v199, v247
    v_mfma_f32_16x16x32_bf16 v[28:31], v[232:235], a[56:59], v[28:31]
    v_perm_b32 v224, v200, v200, v240
    v_perm_b32 v225, v200, v200, v241
    v_perm_b32 v226, v200, v200, v242
    v_perm_b32 v227, v200, v200, v243
    v_mfma_f32_16x16x32_bf16 v[28:31], v[236:239], a[60:63], v[28:31]
    v_perm_b32 v228, v200, v200, v244
    v_perm_b32 v229, v200, v200, v245
    v_perm_b32 v230, v200, v200, v246
    v_perm_b32 v231, v200, v200, v247
    v_mfma_f32_16x16x32_bf16 v[28:31], v[224:227], a[64:67], v[28:31]
    v_perm_b32 v232, v201, v201, v240
    v_perm_b32 v233, v201, v201, v241
    v_perm_b32 v234, v201, v201, v242
    v_perm_b32 v235, v201, v201, v243
    v_mfma_f32_16x16x32_bf16 v[28:31], v[228:231], a[68:71], v[28:31]
    v_perm_b32 v236, v201, v201, v244
    v_perm_b32 v237, v201, v201, v245
    v_perm_b32 v238, v201, v201, v246
    v_perm_b32 v239, v201, v201, v247
    v_mfma_f32_16x16x32_bf16 v[28:31], v[232:235], a[72:75], v[28:31]
    v_perm_b32 v224, v202, v202, v240
    v_perm_b32 v225, v202, v202, v241
    v_perm_b32 v226, v202, v202, v242
    v_perm_b32 v227, v202, v202, v243
    v_mfma_f32_16x16x32_bf16 v[28:31], v[236:239], a[76:79], v[28:31]
    v_perm_b32 v228, v202, v202, v244
    v_perm_b32 v229, v202, v202, v245
    v_perm_b32 v230, v202, v202, v246
    v_perm_b32 v231, v202, v202, v247
    v_mfma_f32_16x16x32_bf16 v[28:31], v[224:227], a[80:83], v[28:31]
    v_perm_b32 v232, v203, v203, v240
    v_perm_b32 v233, v203, v203, v241
    v_perm_b32 v234, v203, v203, v242
    v_perm_b32 v235, v203, v203, v243
    v_mfma_f32_16x16x32_bf16 v[28:31], v[228:231], a[84:87], v[28:31]
    v_perm_b32 v236, v203, v203, v244
    v_perm_b32 v237, v203, v203, v245
    v_perm_b32 v238, v203, v203, v246
    v_perm_b32 v239, v203, v203, v247
    v_mfma_f32_16x16x32_bf16 v[28:31], v[232:235], a[88:91], v[28:31]
    v_perm_b32 v224, v204, v204, v240
    v_perm_b32 v225, v204, v204, v241
    v_perm_b32 v226, v204, v204, v242
    v_perm_b32 v227, v204, v204, v243
    v_mfma_f32_16x16x32_bf16 v[28:31], v[236:239], a[92:95], v[28:31]
    v_perm_b32 v228, v204, v204, v244
    v_perm_b32 v229, v204, v204, v245
    v_perm_b32 v230, v204, v204, v246
    v_perm_b32 v231, v204, v204, v247
    v_mfma_f32_16x16x32_bf16 v[28:31], v[224:227], a[96:99], v[28:31]
    v_perm_b32 v232, v205, v205, v240
    v_perm_b32 v233, v205, v205, v241
    v_perm_b32 v234, v205, v205, v242
    v_perm_b32 v235, v205, v205, v243
    v_mfma_f32_16x16x32_bf16 v[28:31], v[228:231], a[100:103], v[28:31]
    v_perm_b32 v236, v205, v205, v244
    v_perm_b32 v237, v205, v205, v245
    v_perm_b32 v238, v205, v205, v246
    v_perm_b32 v239, v205, v205, v247
    v_mfma_f32_16x16x32_bf16 v[28:31], v[232:235], a[104:107], v[28:31]
    v_perm_b32 v224, v206, v206, v240
    v_perm_b32 v225, v206, v206, v241
    v_perm_b32 v226, v206, v206, v242
    v_perm_b32 v227, v206, v206, v243
    v_mfma_f32_16x16x32_bf16 v[28:31], v[236:239], a[108:111], v[28:31]
    v_perm_b32 v228, v206, v206, v244
    v_perm_b32 v229, v206, v206, v245
    v_perm_b32 v230, v206, v206, v246
    v_perm_b32 v231, v206, v206, v247
    v_mfma_f32_16x16x32_bf16 v[28:31], v[224:227], a[112:115], v[28:31]
    v_perm_b32 v232, v207, v207, v240
    v_perm_b32 v233, v207, v207, v241
    v_perm_b32 v234, v207, v207, v242
    v_perm_b32 v235, v207, v207, v243
    v_mfma_f32_16x16x32_bf16 v[28:31], v[228:231], a[116:119], v[28:31]
    v_perm_b32 v236, v207, v207, v244
    v_perm_b32 v237, v207, v207, v245
    v_perm_b32 v238, v207, v207, v246
    v_perm_b32 v239, v207, v207, v247
    v_mfma_f32_16x16x32_bf16 v[28:31], v[232:235], a[120:123], v[28:31]
    s_nop 1
    v_mfma_f32_16x16x32_bf16 v[28:31], v[236:239], a[124:127], v[28:31]
    s_waitcnt vmcnt(0)
    v_perm_b32 v224, v208, v208, v240
    v_perm_b32 v225, v208, v208, v241
    v_perm_b32 v226, v208, v208, v242
    v_perm_b32 v227, v208, v208, v243
    v_perm_b32 v228, v208, v208, v244
    v_perm_b32 v229, v208, v208, v245
    v_perm_b32 v230, v208, v208, v246
    v_perm_b32 v231, v208, v208, v247
    v_mfma_f32_16x16x32_bf16 v[28:31], v[224:227], a[128:131], v[28:31]
    v_perm_b32 v232, v209, v209, v240
    v_perm_b32 v233, v209, v209, v241
    v_perm_b32 v234, v209, v209, v242
    v_perm_b32 v235, v209, v209, v243
    v_mfma_f32_16x16x32_bf16 v[28:31], v[228:231], a[132:135], v[28:31]
    v_perm_b32 v236, v209, v209, v244
    v_perm_b32 v237, v209, v209, v245
    v_perm_b32 v238, v209, v209, v246
    v_perm_b32 v239, v209, v209, v247
    v_mfma_f32_16x16x32_bf16 v[28:31], v[232:235], a[136:139], v[28:31]
    v_perm_b32 v224, v210, v210, v240
    v_perm_b32 v225, v210, v210, v241
    v_perm_b32 v226, v210, v210, v242
    v_perm_b32 v227, v210, v210, v243
    v_mfma_f32_16x16x32_bf16 v[28:31], v[236:239], a[140:143], v[28:31]
    v_perm_b32 v228, v210, v210, v244
    v_perm_b32 v229, v210, v210, v245
    v_perm_b32 v230, v210, v210, v246
    v_perm_b32 v231, v210, v210, v247
    v_mfma_f32_16x16x32_bf16 v[28:31], v[224:227], a[144:147], v[28:31]
    v_perm_b32 v232, v211, v211, v240
    v_perm_b32 v233, v211, v211, v241
    v_perm_b32 v234, v211, v211, v242
    v_perm_b32 v235, v211, v211, v243
    v_mfma_f32_16x16x32_bf16 v[28:31], v[228:231], a[148:151], v[28:31]
    v_perm_b32 v236, v211, v211, v244
    v_perm_b32 v237, v211, v211, v245
    v_perm_b32 v238, v211, v211, v246
    v_perm_b32 v239, v211, v211, v247
    v_mfma_f32_16x16x32_bf16 v[28:31], v[232:235], a[152:155], v[28:31]
    v_perm_b32 v224, v212, v212, v240
    v_perm_b32 v225, v212, v212, v241
    v_perm_b32 v226, v212, v212, v242
    v_perm_b32 v227, v212, v212, v243
    v_mfma_f32_16x16x32_bf16 v[28:31], v[236:239], a[156:159], v[28:31]
    v_perm_b32 v228, v212, v212, v244
    v_perm_b32 v229, v212, v212, v245
    v_perm_b32 v230, v212, v212, v246
    v_perm_b32 v231, v212, v212, v247
    v_mfma_f32_16x16x32_bf16 v[28:31], v[224:227], a[160:163], v[28:31]
    v_perm_b32 v232, v213, v213, v240
    v_perm_b32 v233, v213, v213, v241
    v_perm_b32 v234, v213, v213, v242
    v_perm_b32 v235, v213, v213, v243
    v_mfma_f32_16x16x32_bf16 v[28:31], v[228:231], a[164:167], v[28:31]
    v_perm_b32 v236, v213, v213, v244
    v_perm_b32 v237, v213, v213, v245
    v_perm_b32 v238, v213, v213, v246
    v_perm_b32 v239, v213, v213, v247
    v_mfma_f32_16x16x32_bf16 v[28:31], v[232:235], a[168:171], v[28:31]
    v_perm_b32 v224, v214, v214, v240
    v_perm_b32 v225, v214, v214, v241
    v_perm_b32 v226, v214, v214, v242
    v_perm_b32 v227, v214, v214, v243
    v_mfma_f32_16x16x32_bf16 v[28:31], v[236:239], a[172:175], v[28:31]
    v_perm_b32 v228, v214, v214, v244
    v_perm_b32 v229, v214, v214, v245
    v_perm_b32 v230, v214, v214, v246
    v_perm_b32 v231, v214, v214, v247
    v_mfma_f32_16x16x32_bf16 v[28:31], v[224:227], a[176:179], v[28:31]
    v_perm_b32 v232, v215, v215, v240
    v_perm_b32 v233, v215, v215, v241
    v_perm_b32 v234, v215, v215, v242
    v_perm_b32 v235, v215, v215, v243
    v_mfma_f32_16x16x32_bf16 v[28:31], v[228:231], a[180:183], v[28:31]
    v_perm_b32 v236, v215, v215, v244
    v_perm_b32 v237, v215, v215, v245
    v_perm_b32 v238, v215, v215, v246
    v_perm_b32 v239, v215, v215, v247
    v_mfma_f32_16x16x32_bf16 v[28:31], v[232:235], a[184:187], v[28:31]
    v_perm_b32 v224, v216, v216, v240
    v_perm_b32 v225, v216, v216, v241
    v_perm_b32 v226, v216, v216, v242
    v_perm_b32 v227, v216, v216, v243
    v_mfma_f32_16x16x32_bf16 v[28:31], v[236:239], a[188:191], v[28:31]
    v_perm_b32 v228, v216, v216, v244
    v_perm_b32 v229, v216, v216, v245
    v_perm_b32 v230, v216, v216, v246
    v_perm_b32 v231, v216, v216, v247
    v_mfma_f32_16x16x32_bf16 v[28:31], v[224:227], a[192:195], v[28:31]
    v_perm_b32 v232, v217, v217, v240
    v_perm_b32 v233, v217, v217, v241
    v_perm_b32 v234, v217, v217, v242
    v_perm_b32 v235, v217, v217, v243
    v_mfma_f32_16x16x32_bf16 v[28:31], v[228:231], a[196:199], v[28:31]
    v_perm_b32 v236, v217, v217, v244
    v_perm_b32 v237, v217, v217, v245
    v_perm_b32 v238, v217, v217, v246
    v_perm_b32 v239, v217, v217, v247
    v_mfma_f32_16x16x32_bf16 v[28:31], v[232:235], a[200:203], v[28:31]
    v_perm_b32 v224, v218, v218, v240
    v_perm_b32 v225, v218, v218, v241
    v_perm_b32 v226, v218, v218, v242
    v_perm_b32 v227, v218, v218, v243
    v_mfma_f32_16x16x32_bf16 v[28:31], v[236:239], a[204:207], v[28:31]
    v_perm_b32 v228, v218, v218, v244
    v_perm_b32 v229, v218, v218, v245
    v_perm_b32 v230, v218, v218, v246
    v_perm_b32 v231, v218, v218, v247
    v_mfma_f32_16x16x32_bf16 v[28:31], v[224:227], a[208:211], v[28:31]
    v_perm_b32 v232, v219, v219, v240
    v_perm_b32 v233, v219, v219, v241
    v_perm_b32 v234, v219, v219, v242
    v_perm_b32 v235, v219, v219, v243
    v_mfma_f32_16x16x32_bf16 v[28:31], v[228:231], a[212:215], v[28:31]
    v_perm_b32 v236, v219, v219, v244
    v_perm_b32 v237, v219, v219, v245
    v_perm_b32 v238, v219, v219, v246
    v_perm_b32 v239, v219, v219, v247
    v_mfma_f32_16x16x32_bf16 v[28:31], v[232:235], a[216:219], v[28:31]
    v_perm_b32 v224, v220, v220, v240
    v_perm_b32 v225, v220, v220, v241
    v_perm_b32 v226, v220, v220, v242
    v_perm_b32 v227, v220, v220, v243
    v_mfma_f32_16x16x32_bf16 v[28:31], v[236:239], a[220:223], v[28:31]
    v_perm_b32 v228, v220, v220, v244
    v_perm_b32 v229, v220, v220, v245
    v_perm_b32 v230, v220, v220, v246
    v_perm_b32 v231, v220, v220, v247
    v_mfma_f32_16x16x32_bf16 v[28:31], v[224:227], a[224:227], v[28:31]
    v_perm_b32 v232, v221, v221, v240
    v_perm_b32 v233, v221, v221, v241
    v_perm_b32 v234, v221, v221, v242
    v_perm_b32 v235, v221, v221, v243
    v_mfma_f32_16x16x32_bf16 v[28:31], v[228:231], a[228:231], v[28:31]
    v_perm_b32 v236, v221, v221, v244
    v_perm_b32 v237, v221, v221, v245
    v_perm_b32 v238, v221, v221, v246
    v_perm_b32 v239, v221, v221, v247
    v_mfma_f32_16x16x32_bf16 v[28:31], v[232:235], a[232:235], v[28:31]
    v_perm_b32 v224, v222, v222, v240
    v_perm_b32 v225, v222, v222, v241
    v_perm_b32 v226, v222, v222, v242
    v_perm_b32 v227, v222, v222, v243
    v_mfma_f32_16x16x32_bf16 v[28:31], v[236:239], a[236:239], v[28:31]
    v_perm_b32 v228, v222, v222, v244
    v_perm_b32 v229, v222, v222, v245
    v_perm_b32 v230, v222, v222, v246
    v_perm_b32 v231, v222, v222, v247
    v_mfma_f32_16x16x32_bf16 v[28:31], v[224:227], a[240:243], v[28:31]
    v_perm_b32 v232, v223, v223, v240
    v_perm_b32 v233, v223, v223, v241
    v_perm_b32 v234, v223, v223, v242
    v_perm_b32 v235, v223, v223, v243
    v_mfma_f32_16x16x32_bf16 v[28:31], v[228:231], a[244:247], v[28:31]
    v_perm_b32 v236, v223, v223, v244
    v_perm_b32 v237, v223, v223, v245
    v_perm_b32 v238, v223, v223, v246
    v_perm_b32 v239, v223, v223, v247
    v_mfma_f32_16x16x32_bf16 v[28:31], v[232:235], a[248:251], v[28:31]
    s_nop 1
    v_mfma_f32_16x16x32_bf16 v[28:31], v[236:239], a[252:255], v[28:31]
    s_mov_b32 s20, s34
    s_mov_b32 s21, s35
    s_mov_b32 s22, 0x200000
    s_mov_b32 s23, 0x20000
    s_mov_b32 s8, s6
    s_mov_b32 s9, s7
    s_mov_b32 s10, 0x2000
    s_mov_b32 s11, 0x20000
    s_lshl_b32 s52, s42, 3
    s_add_u32 s52, s52, s40
    s_lshl_b32 s52, s52, 11
    s_lshl_b32 s53, s3, 9
    s_add_u32 s52, s52, s53
    s_add_u32 s52, s52, 0x110000
    v_lshl_add_u32 v49, v58, 5, s52
    v_lshl_add_u32 v49, v3, 4, v49
    v_cmp_gt_u32 vcc, 2, v3
    s_and_saveexec_b64 s[60:61], vcc
    buffer_store_dwordx4 v[28:31], v49, s[20:23], 0 offen sc1
    s_mov_b64 exec, s[60:61]
    s_waitcnt vmcnt(0)
    s_barrier
    s_lshl_b32 s52, s42, 3
    s_add_u32 s52, s52, s40
    s_lshl_b32 s52, s52, 2
    s_add_u32 s52, s52, s3
    s_lshl_b32 s52, s52, 8
    s_add_u32 s52, s52, 0x100000
    v_and_b32 v60, 31, v2
    v_lshl_add_u32 v60, v60, 3, s52
    v_mov_b32 v61, v250
    v_lshlrev_b32 v62, 2, v3
    s_lshl_b32 s52, s42, 11
    s_lshl_b32 s53, s40, 7
    s_add_u32 s52, s52, s53
    v_lshl_add_u32 v63, v2, 1, s52
    s_cmp_eq_u32 s3, 0
    s_cbranch_scc0 A_WAITB
    s_lshl_b32 s43, s42, 2
    s_add_u32 s53, s43, 128
    v_mov_b32 v47, s53
    v_mov_b32 v48, 1
    s_mov_b64 exec, 1
    buffer_atomic_add v48, v47, s[36:39], 0 offen
    s_mov_b64 exec, -1
    s_mov_b32 s59, 0
    v_mov_b32 v47, s53
A_POLLA:
    buffer_load_dword v48, v47, s[36:39], 0 offen sc1
    s_add_u32 s59, s59, 1
    s_waitcnt vmcnt(0)
    v_readfirstlane_b32 s52, v48
    s_cmp_ge_u32 s52, 8
    s_cbranch_scc1 A_POLLA_ok
    s_sleep 64
    s_cmp_lt_u32 s59, 0x40000
    s_cbranch_scc1 A_POLLA
A_POLLA_ok:
    s_lshl_b32 s52, s42, 14
    s_lshl_b32 s53, s40, 8
    s_add_u32 s52, s52, s53
    s_add_u32 s52, s52, 0x110000
    v_lshl_add_u32 v49, v2, 2, s52
    s_mov_b32 s58, 0
    buffer_load_dword v4, v49, s[20:23], s58 offen offset:0 sc1
    buffer_load_dword v5, v49, s[20:23], s58 offen offset:2048 sc1
    s_mov_b32 s58, 4096
    buffer_load_dword v6, v49, s[20:23], s58 offen offset:0 sc1
    buffer_load_dword v7, v49, s[20:23], s58 offen offset:2048 sc1
    s_mov_b32 s58, 8192
    buffer_load_dword v8, v49, s[20:23], s58 offen offset:0 sc1
    buffer_load_dword v9, v49, s[20:23], s58 offen offset:2048 sc1
    s_mov_b32 s58, 12288
    buffer_load_dword v10, v49, s[20:23], s58 offen offset:0 sc1
    buffer_load_dword v11, v49, s[20:23], s58 offen offset:2048 sc1
    s_waitcnt vmcnt(0)
    v_add_f32 v4, v4, v5
    v_add_f32 v6, v6, v7
    v_add_f32 v8, v8, v9
    v_add_f32 v10, v10, v11
    v_add_f32 v4, v4, v6
    v_add_f32 v8, v8, v10
    v_add_f32 v4, v4, v8
    v_cvt_pk_bf16_f32 v4, v4, v4
    s_nop 0
    buffer_store_short v4, v63, s[8:11], 0 offen sc1
A_WAITB:
    v_and_b32 v47, 3, v2
    v_cmp_gt_u32 s[60:61], s57, v47
    s_mov_b32 s59, 0
    buffer_load_dwordx2 v[8:9], v60, s[20:23], 0 offen sc1
    s_sleep 2
A_POLLP:
    buffer_load_dwordx2 v[10:11], v60, s[20:23], 0 offen sc1
    s_waitcnt vmcnt(1)
    v_max_u32 v6, v8, v9
    v_mov_b32 v4, v8
    v_cmp_eq_u32 vcc, -1, v6
    v_mov_b32 v5, v9
    s_and_b64 vcc, vcc, s[60:61]
    s_cbranch_vccz A_POLLB_ok
    s_sleep 2
    buffer_load_dwordx2 v[8:9], v60, s[20:23], 0 offen sc1
    s_waitcnt vmcnt(1)
    v_max_u32 v6, v10, v11
    v_mov_b32 v4, v10
    v_cmp_eq_u32 vcc, -1, v6
    v_mov_b32 v5, v11
    s_and_b64 vcc, vcc, s[60:61]
    s_cbranch_vccz A_POLLB_ok
    s_sleep 2
    s_add_u32 s59, s59, 1
    s_cmp_lt_u32 s59, 0x20000
    s_cbranch_scc1 A_POLLP
A_POLLB_ok:
    s_mov_b32 s58, 0
    buffer_load_dwordx4 v[64:67], v61, s[20:23], s58 offen sc1
    s_mov_b32 s58, 8192
    buffer_load_dwordx4 v[68:71], v61, s[20:23], s58 offen sc1
    s_mov_b32 s58, 16384
    buffer_load_dwordx4 v[72:75], v61, s[20:23], s58 offen sc1
    s_mov_b32 s58, 24576
    buffer_load_dwordx4 v[76:79], v61, s[20:23], s58 offen sc1
    s_mov_b32 s58, 32768
    buffer_load_dwordx4 v[80:83], v61, s[20:23], s58 offen sc1
    s_mov_b32 s58, 40960
    buffer_load_dwordx4 v[84:87], v61, s[20:23], s58 offen sc1
    s_mov_b32 s58, 49152
    buffer_load_dwordx4 v[88:91], v61, s[20:23], s58 offen sc1
    s_mov_b32 s58, 57344
    buffer_load_dwordx4 v[92:95], v61, s[20:23], s58 offen sc1
    s_mov_b64 vcc, s[60:61]
    v_mov_b32 v48, 0xff800000
    s_lshl_b32 s52, s3, 2
    v_add_u32 v49, s52, v3
    v_lshlrev_b32 v49, 8, v49
    v_lshl_add_u32 v49, v58, 4, v49
    v_cndmask_b32 v4, v48, v4, vcc
    v_cndmask_b32 v5, 0, v5, vcc
    s_nop 0
    v_max_f32_dpp v6, v4, v4 quad_perm:[2,3,0,1] row_mask:0xf bank_mask:0xf
    s_nop 1
    v_max_f32_dpp v6, v6, v6 quad_perm:[1,0,3,2] row_mask:0xf bank_mask:0xf
    v_sub_f32 v4, v4, v6
    v_exp_f32 v4, v4
    s_nop 0
    v_mul_f32 v5, v5, v4
    s_nop 1
    v_add_f32_dpp v5, v5, v5 quad_perm:[2,3,0,1] row_mask:0xf bank_mask:0xf
    s_nop 1
    v_add_f32_dpp v5, v5, v5 quad_perm:[1,0,3,2] row_mask:0xf bank_mask:0xf
    v_rcp_f32 v6, v5
    s_nop 0
    v_fma_f32 v7, -v5, v6, 1.0
    v_fmac_f32 v6, v7, v6
    v_mul_f32 v4, v4, v6
    s_nop 0
    ds_bpermute_b32 v24, v62, v4 offset:0
    ds_bpermute_b32 v25, v62, v4 offset:16
    ds_bpermute_b32 v26, v62, v4 offset:32
    ds_bpermute_b32 v27, v62, v4 offset:48
    ds_bpermute_b32 v28, v62, v4 offset:64
    ds_bpermute_b32 v29, v62, v4 offset:80
    ds_bpermute_b32 v30, v62, v4 offset:96
    ds_bpermute_b32 v31, v62, v4 offset:112
    s_waitcnt vmcnt(7) lgkmcnt(7)
    v_mul_f32 v20, v64, v24
    v_mul_f32 v21, v65, v24
    v_mul_f32 v22, v66, v24
    v_mul_f32 v23, v67, v24
    s_waitcnt vmcnt(6) lgkmcnt(6)
    v_fmac_f32 v20, v68, v25
    v_fmac_f32 v21, v69, v25
    v_fmac_f32 v22, v70, v25
    v_fmac_f32 v23, v71, v25
    s_waitcnt vmcnt(5) lgkmcnt(5)
    v_fmac_f32 v20, v72, v26
    v_fmac_f32 v21, v73, v26
    v_fmac_f32 v22, v74, v26
    v_fmac_f32 v23, v75, v26
    s_waitcnt vmcnt(4) lgkmcnt(4)
    v_fmac_f32 v20, v76, v27
    v_fmac_f32 v21, v77, v27
    v_fmac_f32 v22, v78, v27
    v_fmac_f32 v23, v79, v27
    s_waitcnt vmcnt(3) lgkmcnt(3)
    v_fmac_f32 v20, v80, v28
    v_fmac_f32 v21, v81, v28
    v_fmac_f32 v22, v82, v28
    v_fmac_f32 v23, v83, v28
    s_waitcnt vmcnt(2) lgkmcnt(2)
    v_fmac_f32 v20, v84, v29
    v_fmac_f32 v21, v85, v29
    v_fmac_f32 v22, v86, v29
    v_fmac_f32 v23, v87, v29
    s_waitcnt vmcnt(1) lgkmcnt(1)
    v_fmac_f32 v20, v88, v30
    v_fmac_f32 v21, v89, v30
    v_fmac_f32 v22, v90, v30
    v_fmac_f32 v23, v91, v30
    s_waitcnt vmcnt(0) lgkmcnt(0)
    v_fmac_f32 v20, v92, v31
    v_fmac_f32 v21, v93, v31
    v_fmac_f32 v22, v94, v31
    v_fmac_f32 v23, v95, v31
    ds_write_b128 v49, v[20:23] offset:4096
    v_lshlrev_b32 v47, 2, v2
    s_waitcnt lgkmcnt(0)
    s_barrier
    s_cmp_eq_u32 s3, 0
    s_cbranch_scc0 A_DONE
    ds_read2st64_b32 v[4:5], v47 offset0:16 offset1:17
    ds_read2st64_b32 v[6:7], v47 offset0:18 offset1:19
    ds_read2st64_b32 v[8:9], v47 offset0:20 offset1:21
    ds_read2st64_b32 v[10:11], v47 offset0:22 offset1:23
    ds_read2st64_b32 v[12:13], v47 offset0:24 offset1:25
    ds_read2st64_b32 v[14:15], v47 offset0:26 offset1:27
    ds_read2st64_b32 v[16:17], v47 offset0:28 offset1:29
    ds_read2st64_b32 v[18:19], v47 offset0:30 offset1:31
    s_waitcnt lgkmcnt(0)
    v_add_f32 v4, v4, v5
    v_add_f32 v6, v6, v7
    v_add_f32 v8, v8, v9
    v_add_f32 v10, v10, v11
    v_add_f32 v12, v12, v13
    v_add_f32 v14, v14, v15
    v_add_f32 v16, v16, v17
    v_add_f32 v18, v18, v19
    v_add_f32 v4, v4, v6
    v_add_f32 v8, v8, v10
    v_add_f32 v12, v12, v14
    v_add_f32 v16, v16, v18
    v_add_f32 v4, v4, v8
    v_add_f32 v12, v12, v16
    v_add_f32 v4, v4, v12
    v_cvt_pk_bf16_f32 v4, v4, v4
    s_nop 0
    buffer_store_short v4, v63, s[8:11], 0 offen offset:1024 sc1
A_DONE:
    s_endpgm
.section .rodata,"a"
.p2align 6
.amdhsa_kernel concat_heads__sliding_block_cached__mha_block_cached__decode_kernel
  .amdhsa_next_free_vgpr 512
  .amdhsa_next_free_sgpr 102
  .amdhsa_accum_offset 256
  .amdhsa_group_segment_fixed_size 0
  .amdhsa_kernarg_size 104
  .amdhsa_user_sgpr_count 2
  .amdhsa_user_sgpr_kernarg_segment_ptr 1
  .amdhsa_system_sgpr_workgroup_id_x 1
.end_amdhsa_kernel
```
